```python
import torch

def _softmax(x, axis=-1):
    return torch.softmax(x, dim=axis)
def _gelu(x):
    return torch.nn.functional.gelu(x, approximate="tanh")
def _silu(x):
    return torch.nn.functional.silu(x)
def _sigmoid(x):
    return torch.sigmoid(x)
def _layernorm(x, axis=-1, eps=1e-5):
    m = x.mean(dim=axis, keepdim=True)
    v = x.var(dim=axis, keepdim=True, unbiased=False)
    return (x - m) / torch.sqrt(v + eps)
def _scatter_add(tgt, idx, src, axis=0):
    return tgt.clone().index_add_(axis, idx, src)
def _segment_sum(src, seg, n):
    out = torch.zeros((n,) + src.shape[1:], dtype=src.dtype)
    return out.index_add_(0, seg, src)
def _pad(x, pw):
    flat = tuple(v for pair in reversed(pw) for v in pair)
    return torch.nn.functional.pad(x, flat)

kernel_name = 'parallel_sum__linear_kernel_hedgehog__glu_gated_reglu__prompt'

def setup_inputs():

    _w = (lambda a: (lambda t: t.to(torch.bfloat16) if t.is_floating_point() else t)(torch.as_tensor(a)))
    def _A_setup():
        B, S, D, H = 1, 2048, 448, 16
        Dh = D // H
        return {
            "x": _w((lambda *s: torch.randn(*s, dtype=torch.bfloat16) * 0.05)(B, S, D)),
            "wqkv": _w((lambda *s: torch.randn(*s, dtype=torch.bfloat16) * 0.2)(D, 3 * D)),
            "w_phi": _w((lambda *s: torch.randn(*s, dtype=torch.bfloat16) * 0.2)(H, Dh, Dh) * (Dh ** -0.5)),
            "wo": _w((lambda *s: torch.randn(*s, dtype=torch.bfloat16) * 0.05)(D, D)),
        }
    _A_in = _A_setup()

    def _B_setup():
        B, S, D, F = 1, 2048, 448, 1792
        return {
            "x": _w((lambda *s: torch.randn(*s, dtype=torch.bfloat16) * 0.05)(B, S, D)),
            "W_gate": _w((lambda *s: torch.randn(*s, dtype=torch.bfloat16) * 0.4)(D, F) * (2.0 / D) ** 0.5),
            "W_up": _w((lambda *s: torch.randn(*s, dtype=torch.bfloat16) * 0.4)(D, F) * (2.0 / D) ** 0.5),
            "W_down": _w((lambda *s: torch.randn(*s, dtype=torch.bfloat16) * 0.4)(F, D) * (1.0 / F) ** 0.5),
        }
    _B_in = _B_setup()

    return {
        "A_x": _A_in["x"],
        "A_wqkv": _A_in["wqkv"],
        "A_w_phi": _A_in["w_phi"],
        "A_wo": _A_in["wo"],
        "B_x": _B_in["x"],
        "B_W_gate": _B_in["W_gate"],
        "B_W_up": _B_in["W_up"],
        "B_W_down": _B_in["W_down"],
    }

def reference(A_x, A_wqkv, A_w_phi, A_wo, B_x, B_W_gate, B_W_up, B_W_down):
    def _A_ref(x, wqkv, w_phi, wo):
        B, S, D = x.shape
        H = 16; Dh = D // H
        qkv = (lambda x, *d: x.permute(*d))((x @ wqkv).reshape(B, S, 3, H, Dh), 2, 0, 3, 1, 4)
        q, k, v = qkv[0], qkv[1], qkv[2]
        pq = torch.einsum("bhsd,hdf->bhsf", q, w_phi)
        pk = torch.einsum("bhsd,hdf->bhsf", k, w_phi)
        phi_q = torch.concatenate([_softmax(pq, axis=-1), _softmax(-pq, axis=-1)], axis=-1)
        phi_k = torch.concatenate([_softmax(pk, axis=-1), _softmax(-pk, axis=-1)], axis=-1)
        kv = torch.einsum("bhsf,bhsd->bhfd", phi_k, v)
        z  = torch.einsum("bhsf->bhf", phi_k)
        num = torch.einsum("bhqf,bhfd->bhqd", phi_q, kv)
        den = torch.einsum("bhqf,bhf->bhq", phi_q, z)[..., None] + 1e-6
        o = num / den
        return (lambda x, *d: x.permute(*d))(o, 0, 2, 1, 3).reshape(B, S, D) @ wo

    def _B_ref(x, W_gate, W_up, W_down):
        gate = torch.einsum("bsd,df->bsf", x, W_gate)
        up = torch.einsum("bsd,df->bsf", x, W_up)
        gate = gate * (lambda x, dt: x.to(dt))(gate > 0, gate.dtype)
        h = gate * up
        return torch.einsum("bsf,fd->bsd", h, W_down)

    x = A_x
    xn = _layernorm(x, axis=-1)
    return x + _A_ref(xn, A_wqkv, A_w_phi, A_wo) + _B_ref(xn, B_W_gate, B_W_up, B_W_down)
```

```asm
; @launch grid=(256,1,1) block=(512,1,1) lds=163840
.amdgcn_target "amdgcn-amd-amdhsa--gfx950"
.text
.globl parallel_sum__linear_kernel_hedgehog__glu_gated_reglu__prompt_kernel
.p2align 8
.type parallel_sum__linear_kernel_hedgehog__glu_gated_reglu__prompt_kernel,@function
parallel_sum__linear_kernel_hedgehog__glu_gated_reglu__prompt_kernel:

    s_cmp_ge_u32 s2, 256
    s_cbranch_scc1 L_END
    s_load_dwordx2 s[8:9], s[0:1], 0
    s_load_dwordx2 s[40:41], s[0:1], 8
    v_lshrrev_b32 v2, 6, v0
    v_and_b32 v1, 63, v0
    v_readfirstlane_b32 s3, v2
    s_and_b32 s4, s2, 3
    s_bfe_u32 s5, s2, 0x10002
    s_lshl_b32 s5, s5, 3
    s_bfe_u32 s48, s2, 0x30003
    s_add_u32 s5, s5, s48
    s_lshr_b32 s6, s2, 6
    s_lshl_b32 s7, s3, 10
    s_and_b32 s48, s3, 2
    s_lshl_b32 s48, s48, 2
    s_add_u32 s48, s48, 40
    s_load_dwordx2 s[12:13], s[0:1], s48
    s_bfe_u32 s51, s2, 0x50002
    s_cmp_ge_u32 s51, 7
    s_cselect_b32 s49, 48, 40
    s_cmp_ge_u32 s51, 14
    s_cselect_b32 s49, 8, s49
    s_load_dwordx2 s[16:17], s[0:1], s49
    s_cmp_ge_u32 s2, 98
    s_cselect_b32 s49, 24, 56
    s_load_dwordx2 s[24:25], s[0:1], s49
    s_load_dwordx2 s[20:21], s[0:1], 80
    s_load_dwordx2 s[36:37], s[0:1], 72
    s_load_dwordx2 s[44:45], s[0:1], 16
    s_load_dwordx2 s[28:29], s[0:1], 80
    s_load_dwordx2 s[32:33], s[0:1], 64
    s_mov_b32 s10, 0x1c0000
    s_mov_b32 s11, 0x00020000
    s_mov_b32 s14, 0x188000
    s_mov_b32 s15, 0x00020000
    s_mov_b32 s22, 0x10000000
    s_mov_b32 s23, 0x00020000
    s_mov_b32 s26, 0x188000
    s_mov_b32 s27, 0x00020000
    s_mov_b32 s30, 0x10000000
    s_mov_b32 s31, 0x00020000
    s_mov_b32 s34, 0x1c0000
    s_mov_b32 s35, 0x00020000
    s_mov_b32 s38, 0x100
    s_mov_b32 s39, 0x00020000
    s_mov_b32 s42, 0x126000
    s_mov_b32 s43, 0x00020000
    s_mov_b32 s46, 0x6200
    s_mov_b32 s47, 0x00020000
    s_mov_b32 s18, 0x0
    s_mov_b32 s19, 0x00020000
    v_lshlrev_b32 v10, 4, v1
    v_mov_b32 v14, 0x40000000
    s_lshl_b32 s49, s4, 2
    s_add_u32 s49, s49, s6
    s_lshl_b32 s50, s5, 4
    s_add_u32 s59, s49, s50
    s_lshl_b32 s49, s59, 3
    s_add_u32 s49, s49, s3
    s_mul_i32 s49, s49, 896
    v_add_u32 v12, s49, v10
    v_cmp_gt_u32 vcc, 56, v1
    s_nop 1
    v_cndmask_b32 v118, v14, v12, vcc
    s_and_b32 s54, s5, 7
    s_lshl_b32 s49, s6, 1
    s_add_u32 s54, s54, s49
    s_sub_u32 s49, s54, 7
    s_cselect_b32 s54, s54, s49
    s_cmp_ge_u32 s6, 2
    s_cbranch_scc1 L_A
    v_lshrrev_b32 v12, 3, v1
    s_lshl_b32 s48, s5, 7
    s_lshl_b32 s49, s3, 4
    s_add_u32 s48, s48, s49
    v_add_u32 v13, s48, v12
    v_mul_u32_u24 v13, 896, v13
    v_lshrrev_b32 v14, 4, v1
    v_and_b32 v15, 7, v1
    v_xor_b32 v6, v14, v15
    v_lshl_add_u32 v2, v6, 4, v13
    v_xor_b32 v6, 4, v6
    v_lshl_add_u32 v3, v6, 4, v13
    v_add_u32 v3, 6144, v3
    s_lshr_b32 s48, s3, 2
    s_lshl_b32 s48, s48, 2
    s_and_b32 s49, s3, 1
    s_add_u32 s48, s48, s49
    s_lshl_b32 s48, s48, 2
    s_bfe_u32 s49, s3, 0x10001
    v_lshrrev_b32 v12, 5, v1
    v_bfe_u32 v13, v1, 3, 2
    v_lshl_add_u32 v12, v12, 3, v13
    v_add_u32 v12, s48, v12
    v_mul_u32_u24 v12, 3584, v12
    v_and_b32 v13, 2, v13
    v_bfe_u32 v14, v1, 1, 2
    v_sub_u32 v14, v14, v13
    v_subrev_u32 v14, s49, v14
    v_and_b32 v14, 3, v14
    v_lshl_add_u32 v12, v14, 5, v12
    v_and_b32 v13, 1, v1
    v_lshl_add_u32 v12, v13, 4, v12
    s_mul_i32 s48, s4, 7
    s_mul_i32 s49, s6, 3
    s_add_u32 s57, s48, s49
    s_lshl_b32 s49, s57, 7
    v_add_u32 v4, s49, v12
    s_mov_b32 s50, s51
    s_mov_b32 s46, s54
    s_lshl_b32 s42, s54, 1
    s_waitcnt lgkmcnt(0)
    s_mov_b32 s56, s48
    s_lshr_b32 s48, s2, 4
    s_lshl_b32 s49, s3, 4
    s_add_u32 s48, s48, s49
    s_cmp_lg_u32 s48, 7
    s_cbranch_scc1 SK_1
    v_mov_b32 v120, 0
    v_mov_b32 v121, 0
    v_mov_b32 v122, 0
    v_mov_b32 v123, 0
    s_and_b32 s48, s2, 15
    s_mul_i32 s48, s48, 16384
    s_add_u32 s48, s48, 0x1000000
    buffer_store_dwordx4 v[120:123], v10, s[20:23], s48 offen offset:0 sc1
    buffer_store_dwordx4 v[120:123], v10, s[20:23], s48 offen offset:1024 sc1
    buffer_store_dwordx4 v[120:123], v10, s[20:23], s48 offen offset:2048 sc1
    buffer_store_dwordx4 v[120:123], v10, s[20:23], s48 offen offset:3072 sc1
    s_add_u32 s48, s48, 4096
    buffer_store_dwordx4 v[120:123], v10, s[20:23], s48 offen offset:0 sc1
    buffer_store_dwordx4 v[120:123], v10, s[20:23], s48 offen offset:1024 sc1
    buffer_store_dwordx4 v[120:123], v10, s[20:23], s48 offen offset:2048 sc1
    buffer_store_dwordx4 v[120:123], v10, s[20:23], s48 offen offset:3072 sc1
    s_add_u32 s48, s48, 4096
    buffer_store_dwordx4 v[120:123], v10, s[20:23], s48 offen offset:0 sc1
    buffer_store_dwordx4 v[120:123], v10, s[20:23], s48 offen offset:1024 sc1
    buffer_store_dwordx4 v[120:123], v10, s[20:23], s48 offen offset:2048 sc1
    buffer_store_dwordx4 v[120:123], v10, s[20:23], s48 offen offset:3072 sc1
    s_add_u32 s48, s48, 4096
    buffer_store_dwordx4 v[120:123], v10, s[20:23], s48 offen offset:0 sc1
    buffer_store_dwordx4 v[120:123], v10, s[20:23], s48 offen offset:1024 sc1
    buffer_store_dwordx4 v[120:123], v10, s[20:23], s48 offen offset:2048 sc1
    buffer_store_dwordx4 v[120:123], v10, s[20:23], s48 offen offset:3072 sc1
SK_1:
    buffer_load_dwordx4 v[96:99], v118, s[8:11], 0 offen
    s_lshl_b32 s51, s7, 1
    s_add_u32 m0, s51, 98304
    s_lshl_b32 s51, s46, 7
    buffer_load_dwordx4 v2, s[8:11], s51 offen lds
    buffer_load_dwordx4 v3, s[8:11], s51 offen offset:1024 lds
    s_add_u32 s46, s46, 1
    s_cmp_eq_u32 s46, 7
    s_cselect_b32 s46, 0, s46
    s_mul_i32 s52, s42, 114688
    s_add_u32 s42, s42, 1
    s_cmp_eq_u32 s42, 14
    s_cselect_b32 s42, 0, s42
    s_add_u32 m0, s7, 0
    s_nop 0
    buffer_load_dwordx4 v4, s[12:15], s52 offen offset:0 lds
    s_add_u32 m0, s7, 8064
    s_nop 0
    buffer_load_dwordx4 v4, s[12:15], s52 offen offset:128 lds
    s_add_u32 m0, s7, 16128
    s_nop 0
    buffer_load_dwordx4 v4, s[12:15], s52 offen offset:256 lds
    s_sub_u32 s49, s50, 7
    s_cselect_b32 s49, s50, s49
    s_cselect_b32 s41, 0, 28
    s_add_u32 s48, s56, s49
    s_add_u32 s41, s41, s48
    s_sub_u32 s49, s50, 14
    s_lshr_b32 s51, s49, 1
    s_mul_i32 s51, s51, 7
    s_and_b32 s49, s49, 1
    s_lshl_b32 s52, s4, 1
    s_add_u32 s49, s49, s52
    s_add_u32 s51, s51, s49
    s_add_u32 s52, s51, 56
    s_cmp_ge_u32 s50, 14
    s_cselect_b32 s48, s51, s48
    s_cselect_b32 s41, s52, s41
    s_cselect_b32 s40, 3, 4
    s_mul_i32 s40, s40, 896
    s_cselect_b32 s49, s49, 0
    s_cmp_eq_u32 s49, 7
    s_cselect_b32 s50, 31, s50
    s_lshl_b32 s41, s41, 9
    s_add_u32 s41, s41, 0x1030000
    s_mul_i32 s49, s40, 448
    s_cmp_lt_u32 s50, 20
    s_cselect_b32 s18, s49, 0
    s_cselect_b32 s41, s41, 0x40000000
    s_cselect_b32 s48, s48, 0
    s_lshl_b32 s48, s48, 7
    s_mul_i32 s49, s3, 56
    v_lshrrev_b32 v12, 3, v1
    v_add_u32 v12, s49, v12
    v_mul_u32_u24 v12, s40, v12
    v_and_b32 v13, 7, v1
    v_lshl_add_u32 v12, v13, 4, v12
    v_add_u32 v116, s48, v12
    s_lshl_b32 s40, s40, 3
    s_lshl_b32 s48, s59, 7
    s_lshl_b32 s49, s3, 2
    s_add_u32 s48, s48, s49
    s_add_u32 s48, s48, 0x1020000
    v_mov_b32 v11, s48
    s_mul_i32 s52, s42, 114688
    s_add_u32 s42, s42, 1
    s_cmp_eq_u32 s42, 14
    s_cselect_b32 s42, 0, s42
    s_add_u32 m0, s7, 24576
    s_nop 0
    buffer_load_dwordx4 v4, s[12:15], s52 offen offset:0 lds
    s_add_u32 m0, s7, 32640
    s_nop 0
    buffer_load_dwordx4 v4, s[12:15], s52 offen offset:128 lds
    s_add_u32 m0, s7, 40704
    s_nop 0
    buffer_load_dwordx4 v4, s[12:15], s52 offen offset:256 lds
    v_lshrrev_b32 v12, 5, v1
    v_bfe_u32 v13, v1, 2, 2
    v_and_b32 v14, 3, v1
    v_bfe_u32 v15, v1, 4, 1
    v_bfe_u32 v5, v1, 1, 3
    v_xor_b32 v5, v5, v12
    v_lshlrev_b32 v5, 4, v5
    v_and_b32 v6, 31, v1
    v_lshl_add_u32 v5, v6, 7, v5
    s_and_b32 s48, s3, 1
    s_lshl_b32 s48, s48, 13
    s_add_u32 s48, s48, 98304
    v_add_u32 v5, s48, v5
    v_lshl_add_u32 v9, v12, 2, v13
    v_lshlrev_b32 v9, 7, v9
    v_lshl_add_u32 v9, v15, 11, v9
    v_lshl_add_u32 v9, v14, 3, v9
    v_and_b32 v7, 2, v13
    s_lshr_b32 s48, s3, 1
    v_add3_u32 v7, v7, v15, s48
    v_and_b32 v7, 3, v7
    v_lshl_add_u32 v9, v7, 5, v9
    v_add_u32 v12, 49152, v9
    v_xor_b32 v6, 32, v5
    v_xor_b32 v7, 64, v5
    v_xor_b32 v8, 96, v5
    s_lshl_b32 s49, s5, 1
    s_and_b32 s50, s3, 1
    s_add_u32 s49, s49, s50
    s_mul_i32 s53, s49, 288
    s_lshl_b32 s49, s57, 2
    s_add_u32 s49, s49, s48
    s_add_u32 s53, s53, s49
    s_lshl_b32 s53, s53, 10
    s_lshl_b32 s44, s49, 7
    s_lshr_b32 s48, s2, 3
    s_mul_i32 s49, s48, 37
    s_lshr_b32 s49, s49, 8
    s_mov_b32 s47, s49
    s_mul_i32 s50, s49, 7
    s_sub_u32 s50, s48, s50
    s_and_b32 s48, s2, 7
    s_lshl_b32 s48, s48, 2
    s_add_u32 s48, s48, s49
    s_lshl_b32 s58, s48, 3
    s_add_u32 s58, s58, s50
    s_lshl_b32 s50, s50, 3
    s_add_u32 s50, s50, s3
    s_mul_i32 s57, s50, 36864
    s_add_u32 s57, s57, 0xa00000
    s_lshl_b32 s50, s50, 7
    s_add_u32 s50, s50, 0x103a000
    v_min_u32 v13, 17, v1
    v_lshl_add_u32 v13, v13, 2, s50
    s_lshr_b32 s48, s3, 1
    s_and_b32 s49, s3, 1
    s_mul_i32 s48, s48, 28
    s_mul_i32 s50, s49, 12
    s_add_u32 s55, s48, s50
    s_lshl_b32 s50, s49, 1
    s_add_u32 s56, s48, s50
    s_add_u32 s56, s56, 24
    v_lshrrev_b32 v93, 3, v1
    v_mul_u32_u24 v93, 896, v93
    v_bfe_u32 v94, v1, 4, 1
    v_lshlrev_b32 v94, 2, v94
    v_and_b32 v95, 7, v1
    v_xor_b32 v94, v94, v95
    v_lshl_add_u32 v93, v94, 4, v93
    s_mul_i32 s48, s2, 147
    s_lshr_b32 s48, s48, 10
    s_mul_i32 s49, s48, 7
    s_sub_u32 s49, s2, s49
    v_lshl_add_u32 v93, s49, 7, v93
    s_lshl_b32 s49, s49, 3
    s_add_u32 s49, s49, s3
    s_lshl_b32 s50, s49, 5
    s_add_u32 s50, s50, s48
    s_lshl_b32 s50, s50, 2
    s_add_u32 s50, s50, 0x103a000
    s_cmp_ge_u32 s2, 126
    s_cselect_b32 s50, 0x40000000, s50
    v_mov_b32 v57, s50
    s_mul_i32 s49, s49, 18
    s_add_u32 s49, s49, s48
    s_lshl_b32 s49, s49, 11
    s_add_u32 s49, s49, 0xa00000
    s_cmp_ge_u32 s2, 126
    s_cselect_b32 s49, 0x40000000, s49
    v_add_u32 v56, s49, v10
    s_sub_u32 s49, s55, 2
    s_cmp_lt_u32 s48, 2
    s_cselect_b32 s49, s56, s49
    s_add_u32 s49, s49, s48
    s_lshl_b32 s49, s49, 4
    s_lshr_b32 s50, s48, 4
    s_lshl1_add_u32 s50, s3, s50
    s_mul_i32 s50, s50, 28
    s_and_b32 s48, s48, 1
    s_lshl4_add_u32 s50, s48, s50
    s_cmp_ge_u32 s2, 98
    s_cselect_b32 s49, s50, s49
    s_cselect_b32 s48, s48, 0
    s_cselect_b32 s26, 0x62000, s26
    s_cmp_ge_u32 s2, 126
    s_cselect_b32 s26, 0, s26
    s_mul_i32 s49, s49, 896
    v_add_u32 v44, s49, v93
    s_mul_i32 s48, s48, 0x2000000
    v_and_b32 v94, 32, v1
    v_mul_lo_u32 v94, v94, s48
    v_add_u32 v94, 6144, v94
    v_add_u32 v45, v44, v94
    v_lshrrev_b32 v93, 5, v1
    v_bfe_u32 v94, v1, 2, 2
    v_lshl_add_u32 v93, v93, 2, v94
    v_lshlrev_b32 v93, 7, v93
    v_lshrrev_b32 v94, 1, v94
    v_lshl_add_u32 v93, v94, 6, v93
    v_bfe_u32 v94, v1, 4, 1
    v_lshl_add_u32 v93, v94, 5, v93
    v_and_b32 v94, 3, v1
    v_lshl_add_u32 v93, v94, 3, v93
    s_bfe_u32 s48, s3, 0x10001
    s_lshl_b32 s48, s48, 6
    s_lshr_b32 s49, s3, 2
    s_lshl_b32 s49, s49, 5
    s_add_u32 s48, s48, s49
    s_lshl_b32 s49, s3, 11
    s_add_u32 s48, s48, s49
    s_add_u32 s48, s48, 131072
    v_xor_b32 v46, s48, v93
    v_xor_b32 v47, 64, v46
    s_lshl_b32 s51, s7, 1
    s_add_u32 m0, s51, 131072
    s_nop 0
    buffer_load_dwordx4 v44, s[24:27], 0 offen lds
    buffer_load_dwordx4 v45, s[24:27], 0 offen offset:1024 lds
    s_lshr_b32 s48, s2, 4
    s_lshl_b32 s49, s3, 4
    s_add_u32 s48, s48, s49
    s_cmp_lg_u32 s48, 7
    s_cbranch_scc1 SK_2
    s_waitcnt vmcnt(11)
    s_and_b32 s48, s2, 15
    s_lshl_b32 s48, s48, 2
    v_mov_b32 v120, 1
    v_mov_b32 v121, s48
    s_mov_b64 exec, 1
    buffer_store_dword v120, v121, s[36:39], 0 offen sc1
    s_mov_b64 exec, -1
SK_2:
    s_waitcnt vmcnt(10)
    v_lshlrev_b32 v108, 16, v96
    v_and_b32 v112, 0xffff0000, v96
    v_mul_f32 v109, v108, v108
    v_mul_f32 v113, v112, v112
    v_lshlrev_b32 v110, 16, v97
    v_and_b32 v111, 0xffff0000, v97
    v_add_f32 v108, v108, v110
    v_fmac_f32 v109, v110, v110
    v_add_f32 v112, v112, v111
    v_fmac_f32 v113, v111, v111
    v_lshlrev_b32 v110, 16, v98
    v_and_b32 v111, 0xffff0000, v98
    v_add_f32 v108, v108, v110
    v_fmac_f32 v109, v110, v110
    v_add_f32 v112, v112, v111
    v_fmac_f32 v113, v111, v111
    v_lshlrev_b32 v110, 16, v99
    v_and_b32 v111, 0xffff0000, v99
    v_add_f32 v108, v108, v110
    v_fmac_f32 v109, v110, v110
    v_add_f32 v112, v112, v111
    v_fmac_f32 v113, v111, v111
    v_add_f32 v108, v108, v112
    v_add_f32 v109, v109, v113
    s_nop 0
    v_add_f32_dpp v108, v108, v108 row_shr:1 row_mask:0xf bank_mask:0xf bound_ctrl:0
    v_add_f32_dpp v109, v109, v109 row_shr:1 row_mask:0xf bank_mask:0xf bound_ctrl:0
    s_nop 0
    v_add_f32_dpp v108, v108, v108 row_shr:2 row_mask:0xf bank_mask:0xf bound_ctrl:0
    v_add_f32_dpp v109, v109, v109 row_shr:2 row_mask:0xf bank_mask:0xf bound_ctrl:0
    s_nop 0
    v_add_f32_dpp v108, v108, v108 row_shr:4 row_mask:0xf bank_mask:0xf bound_ctrl:0
    v_add_f32_dpp v109, v109, v109 row_shr:4 row_mask:0xf bank_mask:0xf bound_ctrl:0
    s_nop 0
    v_add_f32_dpp v108, v108, v108 row_shr:8 row_mask:0xf bank_mask:0xf bound_ctrl:0
    v_add_f32_dpp v109, v109, v109 row_shr:8 row_mask:0xf bank_mask:0xf bound_ctrl:0
    s_nop 0
    v_add_f32_dpp v108, v108, v108 row_bcast:15 row_mask:0xa bank_mask:0xf
    v_add_f32_dpp v109, v109, v109 row_bcast:15 row_mask:0xa bank_mask:0xf
    s_nop 0
    v_add_f32_dpp v108, v108, v108 row_bcast:31 row_mask:0xc bank_mask:0xf
    v_add_f32_dpp v109, v109, v109 row_bcast:31 row_mask:0xc bank_mask:0xf
    v_mul_f32 v108, 0xbb124925, v108
    v_mul_f32 v109, 0x3b124925, v109
    v_fma_f32 v109, -v108, v108, v109
    v_cvt_pk_bf16_f32 v110, v108, v108
    v_max_f32 v109, 0, v109
    v_lshlrev_b32 v110, 16, v110
    v_add_f32 v109, 0x3727c5ac, v109
    v_sub_f32 v110, v108, v110
    v_rsq_f32 v96, v109
    v_cvt_pk_bf16_f32 v98, v108, v110
    v_rcp_f32 v97, v109
    v_mov_b32 v99, v98
    s_waitcnt vmcnt(5) lgkmcnt(0)
    s_barrier
    ds_read_b128 v[120:123], v5 offset:0
    ds_read_b64_tr_b16 v[128:129], v9 offset:0
    ds_read_b64_tr_b16 v[130:131], v9 offset:1024
    ds_read_b64_tr_b16 v[132:133], v9 offset:8192
    ds_read_b64_tr_b16 v[134:135], v9 offset:9216
    ds_read_b64_tr_b16 v[136:137], v9 offset:16384
    ds_read_b64_tr_b16 v[138:139], v9 offset:17408
    ds_read_b128 v[124:127], v5 offset:4096
    s_mul_i32 s51, s40, 0
    buffer_load_dwordx4 v[16:19], v116, s[16:19], s51 offen
    s_mul_i32 s51, s40, 1
    buffer_load_dwordx4 v[20:23], v116, s[16:19], s51 offen
    s_mul_i32 s51, s40, 2
    buffer_load_dwordx4 v[24:27], v116, s[16:19], s51 offen
    s_mul_i32 s51, s40, 3
    buffer_load_dwordx4 v[28:31], v116, s[16:19], s51 offen
    s_mul_i32 s51, s40, 4
    buffer_load_dwordx4 v[32:35], v116, s[16:19], s51 offen
    s_mul_i32 s51, s40, 5
    buffer_load_dwordx4 v[36:39], v116, s[16:19], s51 offen
    s_mul_i32 s51, s40, 6
    buffer_load_dwordx4 v[40:43], v116, s[16:19], s51 offen
    s_lshl_b32 s51, s7, 1
    s_add_u32 m0, s51, 114688
    s_lshl_b32 s51, s46, 7
    buffer_load_dwordx4 v2, s[8:11], s51 offen lds
    buffer_load_dwordx4 v3, s[8:11], s51 offen offset:1024 lds
    s_add_u32 s46, s46, 1
    s_cmp_eq_u32 s46, 7
    s_cselect_b32 s46, 0, s46
    s_waitcnt lgkmcnt(5)
    v_mfma_f32_32x32x16_bf16 v[160:175], v[128:131], v[120:123], 0
    ds_read_b128 v[140:143], v6 offset:0
    ds_read_b64_tr_b16 v[148:149], v9 offset:4096
    ds_read_b64_tr_b16 v[150:151], v9 offset:5120
    s_mul_i32 s52, s42, 114688
    s_add_u32 s42, s42, 1
    s_cmp_eq_u32 s42, 14
    s_cselect_b32 s42, 0, s42
    s_add_u32 m0, s7, 49152
    s_nop 0
    buffer_load_dwordx4 v4, s[12:15], s52 offen offset:0 lds
    s_waitcnt lgkmcnt(6)
    v_mfma_f32_32x32x16_bf16 v[176:191], v[132:135], v[120:123], 0
    ds_read_b64_tr_b16 v[152:153], v9 offset:12288
    ds_read_b64_tr_b16 v[154:155], v9 offset:13312
    ds_read_b64_tr_b16 v[156:157], v9 offset:20480
    s_add_u32 m0, s7, 57216
    s_nop 0
    buffer_load_dwordx4 v4, s[12:15], s52 offen offset:128 lds
    s_waitcnt lgkmcnt(7)
    v_mfma_f32_32x32x16_bf16 v[192:207], v[136:139], v[120:123], 0
    ds_read_b64_tr_b16 v[158:159], v9 offset:21504
    ds_read_b128 v[144:147], v6 offset:4096
    s_add_u32 m0, s7, 65280
    s_nop 0
    buffer_load_dwordx4 v4, s[12:15], s52 offen offset:256 lds
    s_waitcnt lgkmcnt(8)
    v_mfma_f32_32x32x16_bf16 v[208:223], v[128:131], v[124:127], 0
    s_mul_i32 s52, s42, 114688
    s_add_u32 s42, s42, 1
    s_cmp_eq_u32 s42, 14
    s_cselect_b32 s42, 0, s42
    s_add_u32 m0, s7, 73728
    s_nop 0
    buffer_load_dwordx4 v4, s[12:15], s52 offen offset:0 lds
    v_mfma_f32_32x32x16_bf16 v[224:239], v[132:135], v[124:127], 0
    s_add_u32 m0, s7, 81792
    s_nop 0
    buffer_load_dwordx4 v4, s[12:15], s52 offen offset:128 lds
    v_mfma_f32_32x32x16_bf16 v[240:255], v[136:139], v[124:127], 0
    s_add_u32 m0, s7, 89856
    s_nop 0
    buffer_load_dwordx4 v4, s[12:15], s52 offen offset:256 lds
    s_cmp_lg_u32 s3, 7
    s_cbranch_scc1 SK_3
    v_and_b32 v14, 15, v1
    v_lshlrev_b32 v14, 2, v14
    buffer_load_dword v14, v14, s[36:39], 0 offen sc1
SK_3:
    s_waitcnt vmcnt(17) lgkmcnt(0)
    s_barrier
    v_mfma_f32_32x32x16_bf16 v[160:175], v[148:151], v[140:143], v[160:175]
    ds_read_b128 v[120:123], v7 offset:0
    ds_read_b64_tr_b16 v[128:129], v9 offset:24576
    ds_read_b64_tr_b16 v[130:131], v9 offset:25600
    s_waitcnt vmcnt(14)
    v_lshlrev_b32 v100, 16, v16
    v_and_b32 v101, 0xffff0000, v16
    v_lshlrev_b32 v102, 16, v17
    v_and_b32 v103, 0xffff0000, v17
    v_lshlrev_b32 v104, 16, v18
    v_and_b32 v105, 0xffff0000, v18
    v_mfma_f32_32x32x16_bf16 v[176:191], v[152:155], v[140:143], v[176:191]
    ds_read_b64_tr_b16 v[132:133], v9 offset:32768
    ds_read_b64_tr_b16 v[134:135], v9 offset:33792
    ds_read_b64_tr_b16 v[136:137], v9 offset:40960
    v_lshlrev_b32 v106, 16, v19
    v_and_b32 v107, 0xffff0000, v19
    s_waitcnt vmcnt(13)
    v_lshlrev_b32 v108, 16, v20
    v_and_b32 v109, 0xffff0000, v20
    v_lshlrev_b32 v110, 16, v21
    v_and_b32 v111, 0xffff0000, v21
    v_mfma_f32_32x32x16_bf16 v[192:207], v[156:159], v[140:143], v[192:207]
    ds_read_b64_tr_b16 v[138:139], v9 offset:41984
    ds_read_b128 v[124:127], v7 offset:4096
    v_add_f32 v100, v100, v108
    v_add_f32 v101, v101, v109
    v_add_f32 v102, v102, v110
    v_add_f32 v103, v103, v111
    v_lshlrev_b32 v108, 16, v22
    v_and_b32 v109, 0xffff0000, v22
    v_mfma_f32_32x32x16_bf16 v[208:223], v[148:151], v[144:147], v[208:223]
    ds_read_b64_tr_b16 v[48:49], v46 offset:0
    ds_read_b64_tr_b16 v[50:51], v46 offset:1024
    ds_read_b64_tr_b16 v[52:53], v47 offset:0
    ds_read_b64_tr_b16 v[54:55], v47 offset:1024
    s_mul_i32 s52, s42, 114688
    s_add_u32 s42, s42, 1
    s_cmp_eq_u32 s42, 14
    s_cselect_b32 s42, 0, s42
    s_add_u32 m0, s7, 0
    s_nop 0
    buffer_load_dwordx4 v4, s[12:15], s52 offen offset:0 lds
    v_lshlrev_b32 v110, 16, v23
    v_and_b32 v111, 0xffff0000, v23
    v_add_f32 v104, v104, v108
    v_add_f32 v105, v105, v109
    v_add_f32 v106, v106, v110
    v_add_f32 v107, v107, v111
    v_mfma_f32_32x32x16_bf16 v[224:239], v[152:155], v[144:147], v[224:239]
    s_add_u32 m0, s7, 8064
    s_nop 0
    buffer_load_dwordx4 v4, s[12:15], s52 offen offset:128 lds
    s_waitcnt vmcnt(14)
    v_lshlrev_b32 v108, 16, v24
    v_and_b32 v109, 0xffff0000, v24
    v_lshlrev_b32 v110, 16, v25
    v_and_b32 v111, 0xffff0000, v25
    v_add_f32 v100, v100, v108
    v_add_f32 v101, v101, v109
    v_mfma_f32_32x32x16_bf16 v[240:255], v[156:159], v[144:147], v[240:255]
    s_add_u32 m0, s7, 16128
    s_nop 0
    buffer_load_dwordx4 v4, s[12:15], s52 offen offset:256 lds
    v_add_f32 v102, v102, v110
    v_add_f32 v103, v103, v111
    v_lshlrev_b32 v108, 16, v26
    v_and_b32 v109, 0xffff0000, v26
    v_lshlrev_b32 v110, 16, v27
    v_and_b32 v111, 0xffff0000, v27
    s_waitcnt lgkmcnt(9)
    v_mfma_f32_32x32x16_bf16 v[160:175], v[128:131], v[120:123], v[160:175]
    ds_read_b128 v[140:143], v8 offset:0
    ds_read_b64_tr_b16 v[148:149], v9 offset:28672
    ds_read_b64_tr_b16 v[150:151], v9 offset:29696
    v_add_f32 v104, v104, v108
    v_add_f32 v105, v105, v109
    v_add_f32 v106, v106, v110
    v_add_f32 v107, v107, v111
    s_waitcnt vmcnt(14)
    v_lshlrev_b32 v108, 16, v28
    v_and_b32 v109, 0xffff0000, v28
    s_waitcnt lgkmcnt(10)
    v_mfma_f32_32x32x16_bf16 v[176:191], v[132:135], v[120:123], v[176:191]
    ds_read_b64_tr_b16 v[152:153], v9 offset:36864
    ds_read_b64_tr_b16 v[154:155], v9 offset:37888
    ds_read_b64_tr_b16 v[156:157], v9 offset:45056
    v_lshlrev_b32 v110, 16, v29
    v_and_b32 v111, 0xffff0000, v29
    v_add_f32 v100, v100, v108
    v_add_f32 v101, v101, v109
    v_add_f32 v102, v102, v110
    v_add_f32 v103, v103, v111
    s_waitcnt lgkmcnt(11)
    v_mfma_f32_32x32x16_bf16 v[192:207], v[136:139], v[120:123], v[192:207]
    ds_read_b64_tr_b16 v[158:159], v9 offset:46080
    ds_read_b128 v[144:147], v8 offset:4096
    v_lshlrev_b32 v108, 16, v30
    v_and_b32 v109, 0xffff0000, v30
    v_lshlrev_b32 v110, 16, v31
    v_and_b32 v111, 0xffff0000, v31
    v_add_f32 v104, v104, v108
    v_add_f32 v105, v105, v109
    s_waitcnt lgkmcnt(12)
    v_mfma_f32_32x32x16_bf16 v[208:223], v[128:131], v[124:127], v[208:223]
    s_waitcnt lgkmcnt(10)
    buffer_store_dwordx4 v[48:51], v56, s[20:23], 0 offen offset:0 sc1
    s_waitcnt lgkmcnt(8)
    buffer_store_dwordx4 v[52:55], v56, s[20:23], 0 offen offset:1024 sc1
    v_add_f32 v106, v106, v110
    v_add_f32 v107, v107, v111
    s_waitcnt vmcnt(15)
    v_lshlrev_b32 v108, 16, v32
    v_and_b32 v109, 0xffff0000, v32
    v_lshlrev_b32 v110, 16, v33
    v_and_b32 v111, 0xffff0000, v33
    v_mfma_f32_32x32x16_bf16 v[224:239], v[132:135], v[124:127], v[224:239]
    v_add_f32 v100, v100, v108
    v_add_f32 v101, v101, v109
    v_add_f32 v102, v102, v110
    v_add_f32 v103, v103, v111
    v_lshlrev_b32 v108, 16, v34
    v_and_b32 v109, 0xffff0000, v34
    v_mfma_f32_32x32x16_bf16 v[240:255], v[136:139], v[124:127], v[240:255]
    s_cmp_lg_u32 s3, 7
    s_cbranch_scc1 SK_4
    s_waitcnt vmcnt(5)
    v_cmp_eq_u32 vcc, 1, v14
    s_cmp_eq_u64 vcc, -1
    s_cbranch_scc1 SPD_6
    s_mov_b32 s54, 50000
SPL_5:
    s_sleep 4
    v_and_b32 v14, 15, v1
    v_lshlrev_b32 v14, 2, v14
    buffer_load_dword v14, v14, s[36:39], 0 offen sc1
    s_waitcnt vmcnt(0)
    s_sub_u32 s54, s54, 1
    s_cbranch_scc1 SPD_6
    v_cmp_eq_u32 vcc, 1, v14
    s_cmp_eq_u64 vcc, -1
    s_cbranch_scc0 SPL_5
SPD_6:
SK_4:
    v_lshlrev_b32 v110, 16, v35
    v_and_b32 v111, 0xffff0000, v35
    v_add_f32 v104, v104, v108
    v_add_f32 v105, v105, v109
    v_add_f32 v106, v106, v110
    v_add_f32 v107, v107, v111
    s_waitcnt vmcnt(8) lgkmcnt(0)
    s_barrier
    v_mfma_f32_32x32x16_bf16 v[160:175], v[148:151], v[140:143], v[160:175]
    ds_read_b128 v[120:123], v5 offset:16384
    ds_read_b64_tr_b16 v[128:129], v12 offset:0
    ds_read_b64_tr_b16 v[130:131], v12 offset:1024
    v_lshlrev_b32 v108, 16, v36
    v_and_b32 v109, 0xffff0000, v36
    v_lshlrev_b32 v110, 16, v37
    v_and_b32 v111, 0xffff0000, v37
    v_add_f32 v100, v100, v108
    v_add_f32 v101, v101, v109
    v_mfma_f32_32x32x16_bf16 v[176:191], v[152:155], v[140:143], v[176:191]
    ds_read_b64_tr_b16 v[132:133], v12 offset:8192
    ds_read_b64_tr_b16 v[134:135], v12 offset:9216
    ds_read_b64_tr_b16 v[136:137], v12 offset:16384
    v_add_f32 v102, v102, v110
    v_add_f32 v103, v103, v111
    v_lshlrev_b32 v108, 16, v38
    v_and_b32 v109, 0xffff0000, v38
    v_lshlrev_b32 v110, 16, v39
    v_and_b32 v111, 0xffff0000, v39
    v_mfma_f32_32x32x16_bf16 v[192:207], v[156:159], v[140:143], v[192:207]
    ds_read_b64_tr_b16 v[138:139], v12 offset:17408
    ds_read_b128 v[124:127], v5 offset:20480
    v_add_f32 v104, v104, v108
    v_add_f32 v105, v105, v109
    v_add_f32 v106, v106, v110
    v_add_f32 v107, v107, v111
    v_lshlrev_b32 v108, 16, v40
    v_and_b32 v109, 0xffff0000, v40
    v_mfma_f32_32x32x16_bf16 v[208:223], v[148:151], v[144:147], v[208:223]
    s_lshl_b32 s51, s7, 1
    s_add_u32 m0, s51, 98304
    s_lshl_b32 s51, s46, 7
    buffer_load_dwordx4 v2, s[8:11], s51 offen lds
    buffer_load_dwordx4 v3, s[8:11], s51 offen offset:1024 lds
    s_add_u32 s46, s46, 1
    s_cmp_eq_u32 s46, 7
    s_cselect_b32 s46, 0, s46
    v_lshlrev_b32 v110, 16, v41
    v_and_b32 v111, 0xffff0000, v41
    v_add_f32 v100, v100, v108
    v_add_f32 v101, v101, v109
    v_add_f32 v102, v102, v110
    v_add_f32 v103, v103, v111
    v_mfma_f32_32x32x16_bf16 v[224:239], v[152:155], v[144:147], v[224:239]
    s_mul_i32 s52, s42, 114688
    s_add_u32 s42, s42, 1
    s_cmp_eq_u32 s42, 14
    s_cselect_b32 s42, 0, s42
    s_add_u32 m0, s7, 24576
    s_nop 0
    buffer_load_dwordx4 v4, s[12:15], s52 offen offset:0 lds
    v_lshlrev_b32 v108, 16, v42
    v_and_b32 v109, 0xffff0000, v42
    v_lshlrev_b32 v110, 16, v43
    v_and_b32 v111, 0xffff0000, v43
    v_add_f32 v104, v104, v108
    v_add_f32 v105, v105, v109
    v_mfma_f32_32x32x16_bf16 v[240:255], v[156:159], v[144:147], v[240:255]
    s_lshl_b32 s51, s59, 3
    s_add_u32 s51, s51, s3
    s_lshl_b32 s51, s51, 4
    s_add_u32 s51, s51, 0x1027c10
    s_mov_b32 exec_lo, 0
    s_mov_b32 exec_hi, 0x80000000
    buffer_store_dwordx4 v[96:99], v10, s[20:23], s51 offen sc1
    s_mov_b64 exec, -1
    v_add_f32 v106, v106, v110
    v_add_f32 v107, v107, v111
    v_permlane32_swap_b32 v100, v101
    v_permlane32_swap_b32 v102, v103
    v_permlane32_swap_b32 v104, v105
    v_permlane32_swap_b32 v106, v107
    s_waitcnt lgkmcnt(5)
    v_mfma_f32_32x32x16_bf16 v[160:175], v[128:131], v[120:123], v[160:175]
    ds_read_b128 v[140:143], v6 offset:16384
    ds_read_b64_tr_b16 v[148:149], v12 offset:4096
    ds_read_b64_tr_b16 v[150:151], v12 offset:5120
    v_add_f32 v100, v100, v101
    v_add_f32 v102, v102, v103
    v_add_f32 v104, v104, v105
    v_add_f32 v106, v106, v107
    v_and_b32 v108, 7, v1
    v_bfe_u32 v109, v1, 4, 1
    s_waitcnt lgkmcnt(6)
    v_mfma_f32_32x32x16_bf16 v[176:191], v[132:135], v[120:123], v[176:191]
    ds_read_b64_tr_b16 v[152:153], v12 offset:12288
    ds_read_b64_tr_b16 v[154:155], v12 offset:13312
    ds_read_b64_tr_b16 v[156:157], v12 offset:20480
    v_permlane16_swap_b32 v100, v102
    v_permlane16_swap_b32 v104, v106
    v_lshlrev_b32 v108, 5, v108
    v_lshl_add_u32 v108, v109, 3, v108
    v_add_f32 v100, v100, v102
    v_add_f32 v104, v104, v106
    s_waitcnt lgkmcnt(7)
    v_mfma_f32_32x32x16_bf16 v[192:207], v[136:139], v[120:123], v[192:207]
    ds_read_b64_tr_b16 v[158:159], v12 offset:21504
    ds_read_b128 v[144:147], v6 offset:20480
    v_lshrrev_b32 v109, 5, v1
    v_lshl_add_u32 v108, v109, 2, v108
    s_lshl_b32 s48, s3, 8
    s_add_u32 s48, s48, 147456
    v_add_u32 v108, s48, v108
    v_add_f32_dpp v100, v100, v100 row_shr:8 row_mask:0xf bank_mask:0xf bound_ctrl:0
    s_waitcnt lgkmcnt(8)
    v_mfma_f32_32x32x16_bf16 v[208:223], v[128:131], v[124:127], v[208:223]
    s_add_u32 m0, s7, 32640
    s_nop 0
    buffer_load_dwordx4 v4, s[12:15], s52 offen offset:128 lds
    v_add_f32_dpp v104, v104, v104 row_shr:8 row_mask:0xf bank_mask:0xf bound_ctrl:0
    s_mov_b32 exec_lo, 0xff00ff00
    s_mov_b32 exec_hi, 0xff00ff00
    ds_write2_b32 v108, v100, v104 offset1:4
    s_mov_b64 exec, -1
    v_mfma_f32_32x32x16_bf16 v[224:239], v[132:135], v[124:127], v[224:239]
    s_add_u32 m0, s7, 40704
    s_nop 0
    buffer_load_dwordx4 v4, s[12:15], s52 offen offset:256 lds
    v_mfma_f32_32x32x16_bf16 v[240:255], v[136:139], v[124:127], v[240:255]
    v_mov_b32 v56, 1
    s_waitcnt vmcnt(6)
    s_mov_b64 exec, 1
    buffer_store_dword v56, v57, s[20:23], 0 offen sc1
    s_mov_b64 exec, -1
    s_mov_b32 s45, 0
    s_waitcnt lgkmcnt(0)
    s_barrier
    v_mfma_f32_32x32x16_bf16 v[160:175], v[148:151], v[140:143], v[160:175]
    ds_read_b128 v[120:123], v7 offset:16384
    ds_read_b64_tr_b16 v[128:129], v12 offset:24576
    ds_read_b64_tr_b16 v[130:131], v12 offset:25600
    v_mfma_f32_32x32x16_bf16 v[176:191], v[152:155], v[140:143], v[176:191]
    ds_read_b64_tr_b16 v[132:133], v12 offset:32768
    ds_read_b64_tr_b16 v[134:135], v12 offset:33792
    ds_read_b64_tr_b16 v[136:137], v12 offset:40960
    v_mfma_f32_32x32x16_bf16 v[192:207], v[156:159], v[140:143], v[192:207]
    ds_read_b64_tr_b16 v[138:139], v12 offset:41984
    ds_read_b128 v[124:127], v7 offset:20480
    v_mfma_f32_32x32x16_bf16 v[208:223], v[148:151], v[144:147], v[208:223]
    s_mul_i32 s52, s42, 114688
    s_add_u32 s42, s42, 1
    s_cmp_eq_u32 s42, 14
    s_cselect_b32 s42, 0, s42
    s_add_u32 m0, s7, 49152
    s_nop 0
    buffer_load_dwordx4 v4, s[12:15], s52 offen offset:0 lds
    v_mfma_f32_32x32x16_bf16 v[224:239], v[152:155], v[144:147], v[224:239]
    s_add_u32 m0, s7, 57216
    s_nop 0
    buffer_load_dwordx4 v4, s[12:15], s52 offen offset:128 lds
    v_mfma_f32_32x32x16_bf16 v[240:255], v[156:159], v[144:147], v[240:255]
    s_add_u32 m0, s7, 65280
    s_nop 0
    buffer_load_dwordx4 v4, s[12:15], s52 offen offset:256 lds
    s_cmp_lg_u32 s3, s45
    s_cbranch_scc1 SK_7
    v_lshlrev_b32 v108, 2, v1
    v_add_u32 v108, 147456, v108
    ds_read2st64_b32 v[100:101], v108 offset0:0 offset1:1
    ds_read2st64_b32 v[102:103], v108 offset0:2 offset1:3
    ds_read2st64_b32 v[104:105], v108 offset0:4 offset1:5
    ds_read2st64_b32 v[106:107], v108 offset0:6 offset1:7
    v_lshl_add_u32 v109, v1, 3, s41
    s_waitcnt lgkmcnt(3)
    v_add_f32 v100, v100, v101
    s_waitcnt lgkmcnt(2)
    v_add_f32 v102, v102, v103
    s_waitcnt lgkmcnt(1)
    v_add_f32 v104, v104, v105
    s_waitcnt lgkmcnt(0)
    v_add_f32 v106, v106, v107
    v_add_f32 v100, v100, v102
    v_add_f32 v104, v104, v106
    v_add_f32 v100, v100, v104
    v_cvt_pk_bf16_f32 v102, v100, v100
    v_lshlrev_b32 v101, 16, v102
    v_sub_f32 v100, v100, v101
    v_cvt_pk_bf16_f32 v103, v100, v100
    v_mov_b32 v100, 0x80008000
    v_cmp_eq_u32 vcc, 0, v103
    s_nop 1
    v_cndmask_b32 v103, v103, v100, vcc
    buffer_store_dwordx2 v[102:103], v109, s[20:23], 0 offen sc1
SK_7:
    s_waitcnt lgkmcnt(5)
    v_mfma_f32_32x32x16_bf16 v[160:175], v[128:131], v[120:123], v[160:175]
    ds_read_b128 v[140:143], v8 offset:16384
    ds_read_b64_tr_b16 v[148:149], v12 offset:28672
    ds_read_b64_tr_b16 v[150:151], v12 offset:29696
    s_waitcnt lgkmcnt(6)
    v_mfma_f32_32x32x16_bf16 v[176:191], v[132:135], v[120:123], v[176:191]
    ds_read_b64_tr_b16 v[152:153], v12 offset:36864
    ds_read_b64_tr_b16 v[154:155], v12 offset:37888
    ds_read_b64_tr_b16 v[156:157], v12 offset:45056
    s_waitcnt lgkmcnt(7)
    v_mfma_f32_32x32x16_bf16 v[192:207], v[136:139], v[120:123], v[192:207]
    ds_read_b64_tr_b16 v[158:159], v12 offset:46080
    ds_read_b128 v[144:147], v8 offset:20480
    s_waitcnt lgkmcnt(8)
    v_mfma_f32_32x32x16_bf16 v[208:223], v[128:131], v[124:127], v[208:223]
    v_mov_b32 v92, -1
    v_mov_b32 v93, -1
    v_mov_b32 v94, -1
    v_mov_b32 v95, -1
    s_add_u32 s51, s53, 0
    buffer_store_dwordx4 v[92:95], v10, s[20:23], s51 offen sc1
    v_mfma_f32_32x32x16_bf16 v[224:239], v[132:135], v[124:127], v[224:239]
    v_mfma_f32_32x32x16_bf16 v[240:255], v[136:139], v[124:127], v[240:255]
    s_add_u32 s51, s53, 4096
    buffer_store_dwordx4 v[92:95], v10, s[20:23], s51 offen sc1
    s_waitcnt vmcnt(10) lgkmcnt(0)
    s_barrier
    v_mfma_f32_32x32x16_bf16 v[160:175], v[148:151], v[140:143], v[160:175]
    ds_read_b128 v[120:123], v5 offset:0
    ds_read_b64_tr_b16 v[128:129], v9 offset:0
    ds_read_b64_tr_b16 v[130:131], v9 offset:1024
    v_mfma_f32_32x32x16_bf16 v[176:191], v[152:155], v[140:143], v[176:191]
    ds_read_b64_tr_b16 v[132:133], v9 offset:8192
    ds_read_b64_tr_b16 v[134:135], v9 offset:9216
    ds_read_b64_tr_b16 v[136:137], v9 offset:16384
    v_mfma_f32_32x32x16_bf16 v[192:207], v[156:159], v[140:143], v[192:207]
    ds_read_b64_tr_b16 v[138:139], v9 offset:17408
    ds_read_b128 v[124:127], v5 offset:4096
    v_mfma_f32_32x32x16_bf16 v[208:223], v[148:151], v[144:147], v[208:223]
    s_lshl_b32 s51, s7, 1
    s_add_u32 m0, s51, 114688
    s_lshl_b32 s51, s46, 7
    buffer_load_dwordx4 v2, s[8:11], s51 offen lds
    buffer_load_dwordx4 v3, s[8:11], s51 offen offset:1024 lds
    s_add_u32 s46, s46, 1
    s_cmp_eq_u32 s46, 7
    s_cselect_b32 s46, 0, s46
    v_mfma_f32_32x32x16_bf16 v[224:239], v[152:155], v[144:147], v[224:239]
    s_mul_i32 s52, s42, 114688
    s_add_u32 s42, s42, 1
    s_cmp_eq_u32 s42, 14
    s_cselect_b32 s42, 0, s42
    s_add_u32 m0, s7, 73728
    s_nop 0
    buffer_load_dwordx4 v4, s[12:15], s52 offen offset:0 lds
    v_mfma_f32_32x32x16_bf16 v[240:255], v[156:159], v[144:147], v[240:255]
    s_add_u32 s51, s53, 8192
    buffer_store_dwordx4 v[92:95], v10, s[20:23], s51 offen sc1
    s_waitcnt lgkmcnt(5)
    v_mfma_f32_32x32x16_bf16 v[160:175], v[128:131], v[120:123], v[160:175]
    ds_read_b128 v[140:143], v6 offset:0
    ds_read_b64_tr_b16 v[148:149], v9 offset:4096
    ds_read_b64_tr_b16 v[150:151], v9 offset:5120
    s_waitcnt lgkmcnt(6)
    v_mfma_f32_32x32x16_bf16 v[176:191], v[132:135], v[120:123], v[176:191]
    ds_read_b64_tr_b16 v[152:153], v9 offset:12288
    ds_read_b64_tr_b16 v[154:155], v9 offset:13312
    ds_read_b64_tr_b16 v[156:157], v9 offset:20480
    s_waitcnt lgkmcnt(7)
    v_mfma_f32_32x32x16_bf16 v[192:207], v[136:139], v[120:123], v[192:207]
    ds_read_b64_tr_b16 v[158:159], v9 offset:21504
    ds_read_b128 v[144:147], v6 offset:4096
    s_waitcnt lgkmcnt(8)
    v_mfma_f32_32x32x16_bf16 v[208:223], v[128:131], v[124:127], v[208:223]
    s_add_u32 m0, s7, 81792
    s_nop 0
    buffer_load_dwordx4 v4, s[12:15], s52 offen offset:128 lds
    v_mfma_f32_32x32x16_bf16 v[224:239], v[132:135], v[124:127], v[224:239]
    s_add_u32 m0, s7, 89856
    s_nop 0
    buffer_load_dwordx4 v4, s[12:15], s52 offen offset:256 lds
    v_mfma_f32_32x32x16_bf16 v[240:255], v[136:139], v[124:127], v[240:255]
    s_add_u32 s51, s53, 147456
    buffer_store_dwordx4 v[92:95], v10, s[20:23], s51 offen sc1
    s_waitcnt vmcnt(13) lgkmcnt(0)
    s_barrier
    v_mfma_f32_32x32x16_bf16 v[160:175], v[148:151], v[140:143], v[160:175]
    ds_read_b128 v[120:123], v7 offset:0
    ds_read_b64_tr_b16 v[128:129], v9 offset:24576
    ds_read_b64_tr_b16 v[130:131], v9 offset:25600
    v_mfma_f32_32x32x16_bf16 v[176:191], v[152:155], v[140:143], v[176:191]
    ds_read_b64_tr_b16 v[132:133], v9 offset:32768
    ds_read_b64_tr_b16 v[134:135], v9 offset:33792
    ds_read_b64_tr_b16 v[136:137], v9 offset:40960
    v_mfma_f32_32x32x16_bf16 v[192:207], v[156:159], v[140:143], v[192:207]
    ds_read_b64_tr_b16 v[138:139], v9 offset:41984
    ds_read_b128 v[124:127], v7 offset:4096
    v_mfma_f32_32x32x16_bf16 v[208:223], v[148:151], v[144:147], v[208:223]
    s_mul_i32 s52, s42, 114688
    s_add_u32 s42, s42, 1
    s_cmp_eq_u32 s42, 14
    s_cselect_b32 s42, 0, s42
    s_add_u32 m0, s7, 0
    s_nop 0
    buffer_load_dwordx4 v4, s[12:15], s52 offen offset:0 lds
    v_mfma_f32_32x32x16_bf16 v[224:239], v[152:155], v[144:147], v[224:239]
    s_add_u32 m0, s7, 8064
    s_nop 0
    buffer_load_dwordx4 v4, s[12:15], s52 offen offset:128 lds
    v_mfma_f32_32x32x16_bf16 v[240:255], v[156:159], v[144:147], v[240:255]
    s_add_u32 m0, s7, 16128
    s_nop 0
    buffer_load_dwordx4 v4, s[12:15], s52 offen offset:256 lds
    s_waitcnt lgkmcnt(5)
    v_mfma_f32_32x32x16_bf16 v[160:175], v[128:131], v[120:123], v[160:175]
    ds_read_b128 v[140:143], v8 offset:0
    ds_read_b64_tr_b16 v[148:149], v9 offset:28672
    ds_read_b64_tr_b16 v[150:151], v9 offset:29696
    s_waitcnt lgkmcnt(6)
    v_mfma_f32_32x32x16_bf16 v[176:191], v[132:135], v[120:123], v[176:191]
    ds_read_b64_tr_b16 v[152:153], v9 offset:36864
    ds_read_b64_tr_b16 v[154:155], v9 offset:37888
    ds_read_b64_tr_b16 v[156:157], v9 offset:45056
    s_waitcnt lgkmcnt(7)
    v_mfma_f32_32x32x16_bf16 v[192:207], v[136:139], v[120:123], v[192:207]
    ds_read_b64_tr_b16 v[158:159], v9 offset:46080
    ds_read_b128 v[144:147], v8 offset:4096
    s_waitcnt lgkmcnt(8)
    v_mfma_f32_32x32x16_bf16 v[208:223], v[128:131], v[124:127], v[208:223]
    s_add_u32 s51, s53, 151552
    buffer_store_dwordx4 v[92:95], v10, s[20:23], s51 offen sc1
    v_mfma_f32_32x32x16_bf16 v[224:239], v[132:135], v[124:127], v[224:239]
    v_mfma_f32_32x32x16_bf16 v[240:255], v[136:139], v[124:127], v[240:255]
    s_add_u32 s51, s53, 155648
    buffer_store_dwordx4 v[92:95], v10, s[20:23], s51 offen sc1
    s_waitcnt vmcnt(10) lgkmcnt(0)
    s_barrier
    v_mfma_f32_32x32x16_bf16 v[160:175], v[148:151], v[140:143], v[160:175]
    ds_read_b128 v[120:123], v5 offset:16384
    ds_read_b64_tr_b16 v[128:129], v12 offset:0
    ds_read_b64_tr_b16 v[130:131], v12 offset:1024
    v_mfma_f32_32x32x16_bf16 v[176:191], v[152:155], v[140:143], v[176:191]
    ds_read_b64_tr_b16 v[132:133], v12 offset:8192
    ds_read_b64_tr_b16 v[134:135], v12 offset:9216
    ds_read_b64_tr_b16 v[136:137], v12 offset:16384
    v_mfma_f32_32x32x16_bf16 v[192:207], v[156:159], v[140:143], v[192:207]
    ds_read_b64_tr_b16 v[138:139], v12 offset:17408
    ds_read_b128 v[124:127], v5 offset:20480
    v_mfma_f32_32x32x16_bf16 v[208:223], v[148:151], v[144:147], v[208:223]
    s_lshl_b32 s51, s7, 1
    s_add_u32 m0, s51, 98304
    s_lshl_b32 s51, s46, 7
    buffer_load_dwordx4 v2, s[8:11], s51 offen lds
    buffer_load_dwordx4 v3, s[8:11], s51 offen offset:1024 lds
    s_add_u32 s46, s46, 1
    s_cmp_eq_u32 s46, 7
    s_cselect_b32 s46, 0, s46
    v_mfma_f32_32x32x16_bf16 v[224:239], v[152:155], v[144:147], v[224:239]
    s_mul_i32 s52, s42, 114688
    s_add_u32 s42, s42, 1
    s_cmp_eq_u32 s42, 14
    s_cselect_b32 s42, 0, s42
    s_add_u32 m0, s7, 24576
    s_nop 0
    buffer_load_dwordx4 v4, s[12:15], s52 offen offset:0 lds
    v_mfma_f32_32x32x16_bf16 v[240:255], v[156:159], v[144:147], v[240:255]
    buffer_load_dword v15, v13, s[20:23], 0 offen sc1
    s_waitcnt lgkmcnt(5)
    v_mfma_f32_32x32x16_bf16 v[160:175], v[128:131], v[120:123], v[160:175]
    ds_read_b128 v[140:143], v6 offset:16384
    ds_read_b64_tr_b16 v[148:149], v12 offset:4096
    ds_read_b64_tr_b16 v[150:151], v12 offset:5120
    s_waitcnt lgkmcnt(6)
    v_mfma_f32_32x32x16_bf16 v[176:191], v[132:135], v[120:123], v[176:191]
    ds_read_b64_tr_b16 v[152:153], v12 offset:12288
    ds_read_b64_tr_b16 v[154:155], v12 offset:13312
    ds_read_b64_tr_b16 v[156:157], v12 offset:20480
    s_waitcnt lgkmcnt(7)
    v_mfma_f32_32x32x16_bf16 v[192:207], v[136:139], v[120:123], v[192:207]
    ds_read_b64_tr_b16 v[158:159], v12 offset:21504
    ds_read_b128 v[144:147], v6 offset:20480
    s_waitcnt lgkmcnt(8)
    v_mfma_f32_32x32x16_bf16 v[208:223], v[128:131], v[124:127], v[208:223]
    s_add_u32 m0, s7, 32640
    s_nop 0
    buffer_load_dwordx4 v4, s[12:15], s52 offen offset:128 lds
    v_mfma_f32_32x32x16_bf16 v[224:239], v[132:135], v[124:127], v[224:239]
    s_add_u32 m0, s7, 40704
    s_nop 0
    buffer_load_dwordx4 v4, s[12:15], s52 offen offset:256 lds
    v_mfma_f32_32x32x16_bf16 v[240:255], v[136:139], v[124:127], v[240:255]
    s_waitcnt vmcnt(12) lgkmcnt(0)
    s_barrier
    v_mfma_f32_32x32x16_bf16 v[160:175], v[148:151], v[140:143], v[160:175]
    ds_read_b128 v[120:123], v7 offset:16384
    ds_read_b64_tr_b16 v[128:129], v12 offset:24576
    ds_read_b64_tr_b16 v[130:131], v12 offset:25600
    v_mfma_f32_32x32x16_bf16 v[176:191], v[152:155], v[140:143], v[176:191]
    ds_read_b64_tr_b16 v[132:133], v12 offset:32768
    ds_read_b64_tr_b16 v[134:135], v12 offset:33792
    ds_read_b64_tr_b16 v[136:137], v12 offset:40960
    v_mfma_f32_32x32x16_bf16 v[192:207], v[156:159], v[140:143], v[192:207]
    ds_read_b64_tr_b16 v[138:139], v12 offset:41984
    ds_read_b128 v[124:127], v7 offset:20480
    v_mfma_f32_32x32x16_bf16 v[208:223], v[148:151], v[144:147], v[208:223]
    s_waitcnt vmcnt(2)
    v_cmp_ne_u32 vcc, 0, v15
    s_cmp_eq_u64 vcc, -1
    s_cbranch_scc1 SPD_9
    s_mov_b32 s54, 50000
SPL_8:
    s_sleep 2
    buffer_load_dword v15, v13, s[20:23], 0 offen sc1
    s_waitcnt vmcnt(0)
    s_sub_u32 s54, s54, 1
    s_cbranch_scc1 SPD_9
    v_cmp_ne_u32 vcc, 0, v15
    s_cmp_eq_u64 vcc, -1
    s_cbranch_scc0 SPL_8
SPD_9:
    s_mul_i32 s52, s42, 114688
    s_add_u32 s42, s42, 1
    s_cmp_eq_u32 s42, 14
    s_cselect_b32 s42, 0, s42
    s_add_u32 m0, s7, 49152
    s_nop 0
    buffer_load_dwordx4 v4, s[12:15], s52 offen offset:0 lds
    v_mfma_f32_32x32x16_bf16 v[224:239], v[152:155], v[144:147], v[224:239]
    s_add_u32 m0, s7, 57216
    s_nop 0
    buffer_load_dwordx4 v4, s[12:15], s52 offen offset:128 lds
    v_mfma_f32_32x32x16_bf16 v[240:255], v[156:159], v[144:147], v[240:255]
    s_add_u32 m0, s7, 65280
    s_nop 0
    buffer_load_dwordx4 v4, s[12:15], s52 offen offset:256 lds
    s_waitcnt lgkmcnt(5)
    v_mfma_f32_32x32x16_bf16 v[160:175], v[128:131], v[120:123], v[160:175]
    ds_read_b128 v[140:143], v8 offset:16384
    ds_read_b64_tr_b16 v[148:149], v12 offset:28672
    ds_read_b64_tr_b16 v[150:151], v12 offset:29696
    s_waitcnt lgkmcnt(6)
    v_mfma_f32_32x32x16_bf16 v[176:191], v[132:135], v[120:123], v[176:191]
    ds_read_b64_tr_b16 v[152:153], v12 offset:36864
    ds_read_b64_tr_b16 v[154:155], v12 offset:37888
    ds_read_b64_tr_b16 v[156:157], v12 offset:45056
    s_waitcnt lgkmcnt(7)
    v_mfma_f32_32x32x16_bf16 v[192:207], v[136:139], v[120:123], v[192:207]
    ds_read_b64_tr_b16 v[158:159], v12 offset:46080
    ds_read_b128 v[144:147], v8 offset:20480
    s_waitcnt lgkmcnt(8)
    v_mfma_f32_32x32x16_bf16 v[208:223], v[128:131], v[124:127], v[208:223]
    s_add_u32 s43, s57, 0
    buffer_load_dwordx4 v[16:19], v10, s[28:31], s43 offen offset:0 sc1
    v_mfma_f32_32x32x16_bf16 v[224:239], v[132:135], v[124:127], v[224:239]
    buffer_load_dwordx4 v[20:23], v10, s[28:31], s43 offen offset:1024 sc1
    v_mfma_f32_32x32x16_bf16 v[240:255], v[136:139], v[124:127], v[240:255]
    v_mov_b32 v92, 1
    s_mov_b64 exec, 1
    buffer_store_dword v92, v11, s[20:23], 0 offen offset:0 sc1
    s_mov_b64 exec, -1
    s_waitcnt lgkmcnt(0)
    s_barrier
    v_mfma_f32_32x32x16_bf16 v[160:175], v[148:151], v[140:143], v[160:175]
    ds_read_b128 v[120:123], v5 offset:0
    ds_read_b64_tr_b16 v[128:129], v9 offset:0
    ds_read_b64_tr_b16 v[130:131], v9 offset:1024
    v_mfma_f32_32x32x16_bf16 v[176:191], v[152:155], v[140:143], v[176:191]
    ds_read_b64_tr_b16 v[132:133], v9 offset:8192
    ds_read_b64_tr_b16 v[134:135], v9 offset:9216
    ds_read_b64_tr_b16 v[136:137], v9 offset:16384
    v_mfma_f32_32x32x16_bf16 v[192:207], v[156:159], v[140:143], v[192:207]
    ds_read_b64_tr_b16 v[138:139], v9 offset:17408
    ds_read_b128 v[124:127], v5 offset:4096
    v_mfma_f32_32x32x16_bf16 v[208:223], v[148:151], v[144:147], v[208:223]
    s_lshl_b32 s51, s7, 1
    s_add_u32 m0, s51, 114688
    s_lshl_b32 s51, s46, 7
    buffer_load_dwordx4 v2, s[8:11], s51 offen lds
    buffer_load_dwordx4 v3, s[8:11], s51 offen offset:1024 lds
    s_add_u32 s46, s46, 1
    s_cmp_eq_u32 s46, 7
    s_cselect_b32 s46, 0, s46
    v_mfma_f32_32x32x16_bf16 v[224:239], v[152:155], v[144:147], v[224:239]
    s_mul_i32 s52, s42, 114688
    s_add_u32 s42, s42, 1
    s_cmp_eq_u32 s42, 14
    s_cselect_b32 s42, 0, s42
    s_add_u32 m0, s7, 73728
    s_nop 0
    buffer_load_dwordx4 v4, s[12:15], s52 offen offset:0 lds
    v_mfma_f32_32x32x16_bf16 v[240:255], v[156:159], v[144:147], v[240:255]
    buffer_load_dwordx4 v[24:27], v10, s[28:31], s43 offen offset:2048 sc1
    s_waitcnt lgkmcnt(5)
    v_mfma_f32_32x32x16_bf16 v[160:175], v[128:131], v[120:123], v[160:175]
    ds_read_b128 v[140:143], v6 offset:0
    ds_read_b64_tr_b16 v[148:149], v9 offset:4096
    ds_read_b64_tr_b16 v[150:151], v9 offset:5120
    s_waitcnt lgkmcnt(6)
    v_mfma_f32_32x32x16_bf16 v[176:191], v[132:135], v[120:123], v[176:191]
    ds_read_b64_tr_b16 v[152:153], v9 offset:12288
    ds_read_b64_tr_b16 v[154:155], v9 offset:13312
    ds_read_b64_tr_b16 v[156:157], v9 offset:20480
    s_waitcnt lgkmcnt(7)
    v_mfma_f32_32x32x16_bf16 v[192:207], v[136:139], v[120:123], v[192:207]
    ds_read_b64_tr_b16 v[158:159], v9 offset:21504
    ds_read_b128 v[144:147], v6 offset:4096
    s_waitcnt lgkmcnt(8)
    v_mfma_f32_32x32x16_bf16 v[208:223], v[128:131], v[124:127], v[208:223]
    s_add_u32 m0, s7, 81792
    s_nop 0
    buffer_load_dwordx4 v4, s[12:15], s52 offen offset:128 lds
    v_mfma_f32_32x32x16_bf16 v[224:239], v[132:135], v[124:127], v[224:239]
    s_add_u32 m0, s7, 89856
    s_nop 0
    buffer_load_dwordx4 v4, s[12:15], s52 offen offset:256 lds
    v_mfma_f32_32x32x16_bf16 v[240:255], v[136:139], v[124:127], v[240:255]
    buffer_load_dwordx4 v[28:31], v10, s[28:31], s43 offen offset:3072 sc1
    s_waitcnt vmcnt(13) lgkmcnt(0)
    s_barrier
    v_mfma_f32_32x32x16_bf16 v[160:175], v[148:151], v[140:143], v[160:175]
    ds_read_b128 v[120:123], v7 offset:0
    ds_read_b64_tr_b16 v[128:129], v9 offset:24576
    ds_read_b64_tr_b16 v[130:131], v9 offset:25600
    v_mfma_f32_32x32x16_bf16 v[176:191], v[152:155], v[140:143], v[176:191]
    ds_read_b64_tr_b16 v[132:133], v9 offset:32768
    ds_read_b64_tr_b16 v[134:135], v9 offset:33792
    ds_read_b64_tr_b16 v[136:137], v9 offset:40960
    v_mfma_f32_32x32x16_bf16 v[192:207], v[156:159], v[140:143], v[192:207]
    ds_read_b64_tr_b16 v[138:139], v9 offset:41984
    ds_read_b128 v[124:127], v7 offset:4096
    v_mfma_f32_32x32x16_bf16 v[208:223], v[148:151], v[144:147], v[208:223]
    s_mul_i32 s52, s42, 114688
    s_add_u32 s42, s42, 1
    s_cmp_eq_u32 s42, 14
    s_cselect_b32 s42, 0, s42
    s_add_u32 m0, s7, 0
    s_nop 0
    buffer_load_dwordx4 v4, s[12:15], s52 offen offset:0 lds
    v_mfma_f32_32x32x16_bf16 v[224:239], v[152:155], v[144:147], v[224:239]
    s_add_u32 m0, s7, 8064
    s_nop 0
    buffer_load_dwordx4 v4, s[12:15], s52 offen offset:128 lds
    v_mfma_f32_32x32x16_bf16 v[240:255], v[156:159], v[144:147], v[240:255]
    s_add_u32 m0, s7, 16128
    s_nop 0
    buffer_load_dwordx4 v4, s[12:15], s52 offen offset:256 lds
    s_waitcnt lgkmcnt(5)
    v_mfma_f32_32x32x16_bf16 v[160:175], v[128:131], v[120:123], v[160:175]
    ds_read_b128 v[140:143], v8 offset:0
    ds_read_b64_tr_b16 v[148:149], v9 offset:28672
    ds_read_b64_tr_b16 v[150:151], v9 offset:29696
    s_waitcnt lgkmcnt(6)
    v_mfma_f32_32x32x16_bf16 v[176:191], v[132:135], v[120:123], v[176:191]
    ds_read_b64_tr_b16 v[152:153], v9 offset:36864
    ds_read_b64_tr_b16 v[154:155], v9 offset:37888
    ds_read_b64_tr_b16 v[156:157], v9 offset:45056
    s_waitcnt lgkmcnt(7)
    v_mfma_f32_32x32x16_bf16 v[192:207], v[136:139], v[120:123], v[192:207]
    ds_read_b64_tr_b16 v[158:159], v9 offset:46080
    ds_read_b128 v[144:147], v8 offset:4096
    s_waitcnt lgkmcnt(8)
    v_mfma_f32_32x32x16_bf16 v[208:223], v[128:131], v[124:127], v[208:223]
    s_add_u32 s43, s47, 0
    s_and_b32 s43, s43, 3
    s_mul_i32 s43, s43, 6144
    s_add_u32 s43, s43, s57
    s_add_u32 s43, s43, 4096
    buffer_load_dwordx4 v[32:35], v10, s[28:31], s43 offen offset:0 sc1
    v_mfma_f32_32x32x16_bf16 v[224:239], v[132:135], v[124:127], v[224:239]
    buffer_load_dwordx4 v[36:39], v10, s[28:31], s43 offen offset:1024 sc1
    v_mfma_f32_32x32x16_bf16 v[240:255], v[136:139], v[124:127], v[240:255]
    s_waitcnt vmcnt(10) lgkmcnt(0)
    s_barrier
    v_mfma_f32_32x32x16_bf16 v[160:175], v[148:151], v[140:143], v[160:175]
    ds_read_b128 v[120:123], v5 offset:16384
    ds_read_b64_tr_b16 v[128:129], v12 offset:0
    ds_read_b64_tr_b16 v[130:131], v12 offset:1024
    v_mfma_f32_32x32x16_bf16 v[176:191], v[152:155], v[140:143], v[176:191]
    ds_read_b64_tr_b16 v[132:133], v12 offset:8192
    ds_read_b64_tr_b16 v[134:135], v12 offset:9216
    ds_read_b64_tr_b16 v[136:137], v12 offset:16384
    v_mfma_f32_32x32x16_bf16 v[192:207], v[156:159], v[140:143], v[192:207]
    ds_read_b64_tr_b16 v[138:139], v12 offset:17408
    ds_read_b128 v[124:127], v5 offset:20480
    v_mfma_f32_32x32x16_bf16 v[208:223], v[148:151], v[144:147], v[208:223]
    s_lshl_b32 s51, s7, 1
    s_add_u32 m0, s51, 98304
    s_lshl_b32 s51, s46, 7
    buffer_load_dwordx4 v2, s[8:11], s51 offen lds
    buffer_load_dwordx4 v3, s[8:11], s51 offen offset:1024 lds
    s_add_u32 s46, s46, 1
    s_cmp_eq_u32 s46, 7
    s_cselect_b32 s46, 0, s46
    v_mfma_f32_32x32x16_bf16 v[224:239], v[152:155], v[144:147], v[224:239]
    s_mul_i32 s52, s42, 114688
    s_add_u32 s42, s42, 1
    s_cmp_eq_u32 s42, 14
    s_cselect_b32 s42, 0, s42
    s_add_u32 m0, s7, 24576
    s_nop 0
    buffer_load_dwordx4 v4, s[12:15], s52 offen offset:0 lds
    v_mfma_f32_32x32x16_bf16 v[240:255], v[156:159], v[144:147], v[240:255]
    buffer_load_dwordx4 v[40:43], v10, s[28:31], s43 offen offset:2048 sc1
    s_waitcnt lgkmcnt(5)
    v_mfma_f32_32x32x16_bf16 v[160:175], v[128:131], v[120:123], v[160:175]
    ds_read_b128 v[140:143], v6 offset:16384
    ds_read_b64_tr_b16 v[148:149], v12 offset:4096
    ds_read_b64_tr_b16 v[150:151], v12 offset:5120
    s_waitcnt lgkmcnt(6)
    v_mfma_f32_32x32x16_bf16 v[176:191], v[132:135], v[120:123], v[176:191]
    ds_read_b64_tr_b16 v[152:153], v12 offset:12288
    ds_read_b64_tr_b16 v[154:155], v12 offset:13312
    ds_read_b64_tr_b16 v[156:157], v12 offset:20480
    s_waitcnt lgkmcnt(7)
    v_mfma_f32_32x32x16_bf16 v[192:207], v[136:139], v[120:123], v[192:207]
    ds_read_b64_tr_b16 v[158:159], v12 offset:21504
    ds_read_b128 v[144:147], v6 offset:20480
    s_waitcnt lgkmcnt(8)
    v_mfma_f32_32x32x16_bf16 v[208:223], v[128:131], v[124:127], v[208:223]
    s_add_u32 m0, s7, 32640
    s_nop 0
    buffer_load_dwordx4 v4, s[12:15], s52 offen offset:128 lds
    v_mfma_f32_32x32x16_bf16 v[224:239], v[132:135], v[124:127], v[224:239]
    s_add_u32 m0, s7, 40704
    s_nop 0
    buffer_load_dwordx4 v4, s[12:15], s52 offen offset:256 lds
    v_mfma_f32_32x32x16_bf16 v[240:255], v[136:139], v[124:127], v[240:255]
    buffer_load_dwordx4 v[44:47], v10, s[28:31], s43 offen offset:3072 sc1
    s_waitcnt vmcnt(13) lgkmcnt(0)
    s_barrier
    v_mfma_f32_32x32x16_bf16 v[160:175], v[148:151], v[140:143], v[160:175]
    ds_read_b128 v[120:123], v7 offset:16384
    ds_read_b64_tr_b16 v[128:129], v12 offset:24576
    ds_read_b64_tr_b16 v[130:131], v12 offset:25600
    v_mfma_f32_32x32x16_bf16 v[176:191], v[152:155], v[140:143], v[176:191]
    ds_read_b64_tr_b16 v[132:133], v12 offset:32768
    ds_read_b64_tr_b16 v[134:135], v12 offset:33792
    ds_read_b64_tr_b16 v[136:137], v12 offset:40960
    v_mfma_f32_32x32x16_bf16 v[192:207], v[156:159], v[140:143], v[192:207]
    ds_read_b64_tr_b16 v[138:139], v12 offset:41984
    ds_read_b128 v[124:127], v7 offset:20480
    v_mfma_f32_32x32x16_bf16 v[208:223], v[148:151], v[144:147], v[208:223]
    s_add_u32 s43, s43, 4096
    buffer_load_dwordx4 v[48:51], v10, s[28:31], s43 offen offset:0 sc1
    v_mfma_f32_32x32x16_bf16 v[224:239], v[152:155], v[144:147], v[224:239]
    buffer_load_dwordx4 v[52:55], v10, s[28:31], s43 offen offset:1024 sc1
    v_mfma_f32_32x32x16_bf16 v[240:255], v[156:159], v[144:147], v[240:255]
    s_add_u32 s43, s47, 1
    s_and_b32 s43, s43, 3
    s_mul_i32 s43, s43, 6144
    s_add_u32 s43, s43, s57
    s_add_u32 s43, s43, 4096
    buffer_load_dwordx4 v[56:59], v10, s[28:31], s43 offen offset:0 sc1
    v_and_b32 v118, 31, v1
    v_lshlrev_b32 v119, 4, v118
    s_lshl_b32 s48, s5, 1
    s_and_b32 s49, s3, 1
    s_add_u32 s48, s48, s49
    s_lshl_b32 s48, s48, 10
    s_add_u32 s48, s48, 0x1028000
    buffer_load_dwordx4 v[96:99], v119, s[20:23], s48 offen offset:0 sc1
    buffer_load_dwordx4 v[102:105], v119, s[20:23], s48 offen offset:512 sc1
    v_and_b32 v119, 15, v1
    v_lshlrev_b32 v119, 3, v119
    v_lshrrev_b32 v118, 4, v1
    v_mul_u32_u24 v14, 14336, v118
    v_add_u32 v119, v119, v14
    v_lshrrev_b32 v118, 1, v118
    v_lshl_add_u32 v119, v118, 30, v119
    s_add_u32 s48, s44, 0x1030000
    buffer_load_dwordx2 v[108:109], v119, s[20:23], s48 offen offset:0 sc1
    buffer_load_dwordx2 v[112:113], v119, s[20:23], s48 offen offset:512 sc1
    buffer_load_dwordx2 v[116:117], v119, s[20:23], s48 offen offset:1024 sc1
    s_waitcnt lgkmcnt(5)
    v_mfma_f32_32x32x16_bf16 v[160:175], v[128:131], v[120:123], v[160:175]
    ds_read_b128 v[140:143], v8 offset:16384
    ds_read_b64_tr_b16 v[148:149], v12 offset:28672
    ds_read_b64_tr_b16 v[150:151], v12 offset:29696
    s_waitcnt lgkmcnt(6)
    v_mfma_f32_32x32x16_bf16 v[176:191], v[132:135], v[120:123], v[176:191]
    ds_read_b64_tr_b16 v[152:153], v12 offset:36864
    ds_read_b64_tr_b16 v[154:155], v12 offset:37888
    ds_read_b64_tr_b16 v[156:157], v12 offset:45056
    s_waitcnt lgkmcnt(7)
    v_mfma_f32_32x32x16_bf16 v[192:207], v[136:139], v[120:123], v[192:207]
    ds_read_b64_tr_b16 v[158:159], v12 offset:46080
    ds_read_b128 v[144:147], v8 offset:20480
    s_waitcnt lgkmcnt(8)
    v_mfma_f32_32x32x16_bf16 v[208:223], v[128:131], v[124:127], v[208:223]
    buffer_load_dwordx4 v[60:63], v10, s[28:31], s43 offen offset:1024 sc1
    v_mfma_f32_32x32x16_bf16 v[224:239], v[132:135], v[124:127], v[224:239]
    buffer_load_dwordx4 v[64:67], v10, s[28:31], s43 offen offset:2048 sc1
    v_mfma_f32_32x32x16_bf16 v[240:255], v[136:139], v[124:127], v[240:255]
    buffer_load_dwordx4 v[68:71], v10, s[28:31], s43 offen offset:3072 sc1
    s_waitcnt vmcnt(16) lgkmcnt(0)
    s_barrier
    v_mfma_f32_32x32x16_bf16 v[160:175], v[148:151], v[140:143], v[160:175]
    ds_read_b128 v[120:123], v5 offset:0
    ds_read_b64_tr_b16 v[128:129], v9 offset:0
    ds_read_b64_tr_b16 v[130:131], v9 offset:1024
    v_mfma_f32_32x32x16_bf16 v[176:191], v[152:155], v[140:143], v[176:191]
    ds_read_b64_tr_b16 v[132:133], v9 offset:8192
    ds_read_b64_tr_b16 v[134:135], v9 offset:9216
    ds_read_b64_tr_b16 v[136:137], v9 offset:16384
    v_mfma_f32_32x32x16_bf16 v[192:207], v[156:159], v[140:143], v[192:207]
    ds_read_b64_tr_b16 v[138:139], v9 offset:17408
    ds_read_b128 v[124:127], v5 offset:4096
    v_mfma_f32_32x32x16_bf16 v[208:223], v[148:151], v[144:147], v[208:223]
    s_add_u32 s43, s43, 4096
    buffer_load_dwordx4 v[72:75], v10, s[28:31], s43 offen offset:0 sc1
    v_mfma_f32_32x32x16_bf16 v[224:239], v[152:155], v[144:147], v[224:239]
    buffer_load_dwordx4 v[76:79], v10, s[28:31], s43 offen offset:1024 sc1
    v_mfma_f32_32x32x16_bf16 v[240:255], v[156:159], v[144:147], v[240:255]
    s_add_u32 s43, s47, 2
    s_and_b32 s43, s43, 3
    s_mul_i32 s43, s43, 6144
    s_add_u32 s43, s43, s57
    s_add_u32 s43, s43, 4096
    buffer_load_dwordx4 v[80:83], v10, s[28:31], s43 offen offset:0 sc1
    s_waitcnt lgkmcnt(5)
    v_mfma_f32_32x32x16_bf16 v[160:175], v[128:131], v[120:123], v[160:175]
    ds_read_b128 v[140:143], v6 offset:0
    ds_read_b64_tr_b16 v[148:149], v9 offset:4096
    ds_read_b64_tr_b16 v[150:151], v9 offset:5120
    s_waitcnt lgkmcnt(6)
    v_mfma_f32_32x32x16_bf16 v[176:191], v[132:135], v[120:123], v[176:191]
    ds_read_b64_tr_b16 v[152:153], v9 offset:12288
    ds_read_b64_tr_b16 v[154:155], v9 offset:13312
    ds_read_b64_tr_b16 v[156:157], v9 offset:20480
    s_waitcnt lgkmcnt(7)
    v_mfma_f32_32x32x16_bf16 v[192:207], v[136:139], v[120:123], v[192:207]
    ds_read_b64_tr_b16 v[158:159], v9 offset:21504
    ds_read_b128 v[144:147], v6 offset:4096
    s_waitcnt lgkmcnt(8)
    v_mfma_f32_32x32x16_bf16 v[208:223], v[128:131], v[124:127], v[208:223]
    buffer_load_dwordx4 v[84:87], v10, s[28:31], s43 offen offset:1024 sc1
    v_mfma_f32_32x32x16_bf16 v[224:239], v[132:135], v[124:127], v[224:239]
    buffer_load_dwordx4 v[88:91], v10, s[28:31], s43 offen offset:2048 sc1
    v_mfma_f32_32x32x16_bf16 v[240:255], v[136:139], v[124:127], v[240:255]
    s_lshr_b32 s49, s58, 3
    s_and_b32 s48, s3, 1
    s_lshr_b32 s50, s49, 1
    s_and_b32 s49, s49, 1
    s_lshl_b32 s50, s50, 4
    s_lshr_b32 s51, s3, 1
    s_lshl_b32 s51, s51, 2
    s_add_u32 s50, s50, s51
    s_add_u32 s50, s50, s48
    s_lshl_b32 s50, s50, 7
    s_add_u32 s50, s50, 0x1020000
    s_lshl_b32 s49, s49, 2
    s_add_u32 s50, s50, s49
    v_and_b32 v14, 3, v1
    v_lshl_add_u32 v13, v14, 3, s50
    s_add_u32 s50, s50, s49
    s_add_u32 s50, s50, 256
    v_and_b32 v14, 1, v1
    v_bfe_u32 v15, v1, 1, 1
    v_lshlrev_b32 v14, 2, v14
    v_lshl_add_u32 v14, v15, 4, v14
    v_add_u32 v14, s50, v14
    v_cmp_gt_u32 vcc, 4, v1
    s_nop 1
    v_cndmask_b32 v13, v14, v13, vcc
    buffer_load_dword v15, v13, s[20:23], 0 offen sc1
    buffer_load_dwordx4 v[92:95], v10, s[28:31], s43 offen offset:3072 sc1
    s_waitcnt vmcnt(19) lgkmcnt(0)
    s_barrier
    v_mfma_f32_32x32x16_bf16 v[160:175], v[148:151], v[140:143], v[160:175]
    ds_read_b128 v[120:123], v7 offset:0
    ds_read_b64_tr_b16 v[128:129], v9 offset:24576
    ds_read_b64_tr_b16 v[130:131], v9 offset:25600
    v_mfma_f32_32x32x16_bf16 v[176:191], v[152:155], v[140:143], v[176:191]
    ds_read_b64_tr_b16 v[132:133], v9 offset:32768
    ds_read_b64_tr_b16 v[134:135], v9 offset:33792
    ds_read_b64_tr_b16 v[136:137], v9 offset:40960
    v_mfma_f32_32x32x16_bf16 v[192:207], v[156:159], v[140:143], v[192:207]
    ds_read_b64_tr_b16 v[138:139], v9 offset:41984
    ds_read_b128 v[124:127], v7 offset:4096
    v_mfma_f32_32x32x16_bf16 v[208:223], v[148:151], v[144:147], v[208:223]
    v_mfma_f32_32x32x16_bf16 v[224:239], v[152:155], v[144:147], v[224:239]
    v_mfma_f32_32x32x16_bf16 v[240:255], v[156:159], v[144:147], v[240:255]
    s_waitcnt lgkmcnt(5)
    v_mfma_f32_32x32x16_bf16 v[160:175], v[128:131], v[120:123], v[160:175]
    ds_read_b128 v[140:143], v8 offset:0
    ds_read_b64_tr_b16 v[148:149], v9 offset:28672
    ds_read_b64_tr_b16 v[150:151], v9 offset:29696
    s_waitcnt lgkmcnt(6)
    v_mfma_f32_32x32x16_bf16 v[176:191], v[132:135], v[120:123], v[176:191]
    ds_read_b64_tr_b16 v[152:153], v9 offset:36864
    ds_read_b64_tr_b16 v[154:155], v9 offset:37888
    ds_read_b64_tr_b16 v[156:157], v9 offset:45056
    s_waitcnt lgkmcnt(7)
    v_mfma_f32_32x32x16_bf16 v[192:207], v[136:139], v[120:123], v[192:207]
    ds_read_b64_tr_b16 v[158:159], v9 offset:46080
    ds_read_b128 v[144:147], v8 offset:4096
    s_waitcnt lgkmcnt(8)
    v_mfma_f32_32x32x16_bf16 v[208:223], v[128:131], v[124:127], v[208:223]
    v_mfma_f32_32x32x16_bf16 v[224:239], v[132:135], v[124:127], v[224:239]
    v_mfma_f32_32x32x16_bf16 v[240:255], v[136:139], v[124:127], v[240:255]
    s_setprio 1
    s_waitcnt lgkmcnt(5)
    v_mfma_f32_32x32x16_bf16 v[160:175], v[148:151], v[140:143], v[160:175]
    s_waitcnt lgkmcnt(3)
    v_mfma_f32_32x32x16_bf16 v[176:191], v[152:155], v[140:143], v[176:191]
    s_waitcnt lgkmcnt(1)
    v_mfma_f32_32x32x16_bf16 v[192:207], v[156:159], v[140:143], v[192:207]
    s_waitcnt vmcnt(13)
    v_min_u32 v110, v96, v102
    s_waitcnt vmcnt(10)
    v_min3_u32 v111, v109, v113, v117
    v_cmp_ne_u32 s[16:17], 0, v111
    v_cmp_ne_u32 vcc, 0, v110
    s_and_b32 vcc_lo, vcc_lo, s16
    s_cmp_eq_u64 vcc, -1
    s_cbranch_scc1 SPD_11
    s_mov_b32 s54, 50000
SPL_10:
    s_sleep 2
    v_and_b32 v118, 31, v1
    v_lshlrev_b32 v119, 4, v118
    s_lshl_b32 s48, s5, 1
    s_and_b32 s49, s3, 1
    s_add_u32 s48, s48, s49
    s_lshl_b32 s48, s48, 10
    s_add_u32 s48, s48, 0x1028000
    buffer_load_dwordx4 v[96:99], v119, s[20:23], s48 offen offset:0 sc1
    buffer_load_dwordx4 v[102:105], v119, s[20:23], s48 offen offset:512 sc1
    v_and_b32 v119, 15, v1
    v_lshlrev_b32 v119, 3, v119
    v_lshrrev_b32 v118, 4, v1
    v_mul_u32_u24 v14, 14336, v118
    v_add_u32 v119, v119, v14
    v_lshrrev_b32 v118, 1, v118
    v_lshl_add_u32 v119, v118, 30, v119
    s_add_u32 s48, s44, 0x1030000
    buffer_load_dwordx2 v[108:109], v119, s[20:23], s48 offen offset:0 sc1
    buffer_load_dwordx2 v[112:113], v119, s[20:23], s48 offen offset:512 sc1
    buffer_load_dwordx2 v[116:117], v119, s[20:23], s48 offen offset:1024 sc1
    s_waitcnt vmcnt(0)
    s_sub_u32 s54, s54, 1
    s_cbranch_scc1 SPD_11
    v_min_u32 v110, v96, v102
    v_min3_u32 v111, v109, v113, v117
    v_cmp_ne_u32 s[16:17], 0, v111
    v_cmp_ne_u32 vcc, 0, v110
    s_and_b32 vcc_lo, vcc_lo, s16
    s_cmp_eq_u64 vcc, -1
    s_cbranch_scc0 SPL_10
SPD_11:
    v_mov_b32 v100, 0
    v_mov_b32 v101, 0
    v_mov_b32 v106, 0
    v_mov_b32 v107, 0
    v_mov_b32 v110, 0
    s_waitcnt lgkmcnt(0)
    v_mfma_f32_32x32x16_bf16 v[208:223], v[148:151], v[144:147], v[208:223]
    v_mov_b32 v111, 0
    v_mov_b32 v114, 0
    v_mov_b32 v115, 0
    v_mov_b32 v118, 0
    v_mov_b32 v119, 0
    v_mfma_f32_32x32x16_bf16 v[224:239], v[152:155], v[144:147], v[224:239]
    v_mfma_f32_32x32x16_bf16 v[240:255], v[156:159], v[144:147], v[240:255]
    v_mfma_f32_32x32x16_bf16 v[160:175], v[108:111], v[98:101], v[160:175]
    v_mfma_f32_32x32x16_bf16 v[176:191], v[112:115], v[98:101], v[176:191]
    v_mfma_f32_32x32x16_bf16 v[192:207], v[116:119], v[98:101], v[192:207]
    v_mfma_f32_32x32x16_bf16 v[208:223], v[108:111], v[104:107], v[208:223]
    v_mfma_f32_32x32x16_bf16 v[224:239], v[112:115], v[104:107], v[224:239]
    v_mfma_f32_32x32x16_bf16 v[240:255], v[116:119], v[104:107], v[240:255]
    v_mul_f32 v96, 0x2b800000, v97
    v_mul_f32 v97, 0x2b800000, v97
    v_mul_f32 v102, 0x2b800000, v103
    v_mul_f32 v103, 0x2b800000, v103
    s_add_u32 s48, s53, 0
    s_nop 1
    v_pk_mul_f32 v[160:161], v[160:161], v[96:97] clamp
    v_pk_mul_f32 v[162:163], v[162:163], v[96:97] clamp
    v_pk_mul_f32 v[164:165], v[164:165], v[96:97] clamp
    v_pk_mul_f32 v[166:167], v[166:167], v[96:97] clamp
    v_pk_mul_f32 v[160:161], v[160:161], v[168:169]
    v_pk_mul_f32 v[162:163], v[162:163], v[170:171]
    v_pk_mul_f32 v[164:165], v[164:165], v[172:173]
    v_pk_mul_f32 v[166:167], v[166:167], v[174:175]
    v_cvt_pk_bf16_f32 v160, v160, v161
    v_cvt_pk_bf16_f32 v161, v162, v163
    v_cvt_pk_bf16_f32 v162, v164, v165
    v_cvt_pk_bf16_f32 v163, v166, v167
    buffer_store_dwordx4 v[160:163], v10, s[20:23], s48 offen offset:0 sc1
    s_add_u32 s48, s48, 4096
    v_pk_mul_f32 v[176:177], v[176:177], v[96:97] clamp
    v_pk_mul_f32 v[178:179], v[178:179], v[96:97] clamp
    v_pk_mul_f32 v[180:181], v[180:181], v[96:97] clamp
    v_pk_mul_f32 v[182:183], v[182:183], v[96:97] clamp
    v_pk_mul_f32 v[176:177], v[176:177], v[184:185]
    v_pk_mul_f32 v[178:179], v[178:179], v[186:187]
    v_pk_mul_f32 v[180:181], v[180:181], v[188:189]
    v_pk_mul_f32 v[182:183], v[182:183], v[190:191]
    v_cvt_pk_bf16_f32 v176, v176, v177
    v_cvt_pk_bf16_f32 v177, v178, v179
    v_cvt_pk_bf16_f32 v178, v180, v181
    v_cvt_pk_bf16_f32 v179, v182, v183
    buffer_store_dwordx4 v[176:179], v10, s[20:23], s48 offen offset:0 sc1
    s_add_u32 s48, s48, 4096
    v_pk_mul_f32 v[192:193], v[192:193], v[96:97] clamp
    v_pk_mul_f32 v[194:195], v[194:195], v[96:97] clamp
    v_pk_mul_f32 v[196:197], v[196:197], v[96:97] clamp
    v_pk_mul_f32 v[198:199], v[198:199], v[96:97] clamp
    v_pk_mul_f32 v[192:193], v[192:193], v[200:201]
    v_pk_mul_f32 v[194:195], v[194:195], v[202:203]
    v_pk_mul_f32 v[196:197], v[196:197], v[204:205]
    v_pk_mul_f32 v[198:199], v[198:199], v[206:207]
    v_cvt_pk_bf16_f32 v192, v192, v193
    v_cvt_pk_bf16_f32 v193, v194, v195
    v_cvt_pk_bf16_f32 v194, v196, v197
    v_cvt_pk_bf16_f32 v195, v198, v199
    buffer_store_dwordx4 v[192:195], v10, s[20:23], s48 offen offset:0 sc1
    s_add_u32 s48, s53, 147456
    v_pk_mul_f32 v[208:209], v[208:209], v[102:103] clamp
    v_pk_mul_f32 v[210:211], v[210:211], v[102:103] clamp
    v_pk_mul_f32 v[212:213], v[212:213], v[102:103] clamp
    v_pk_mul_f32 v[214:215], v[214:215], v[102:103] clamp
    v_pk_mul_f32 v[208:209], v[208:209], v[216:217]
    v_pk_mul_f32 v[210:211], v[210:211], v[218:219]
    v_pk_mul_f32 v[212:213], v[212:213], v[220:221]
    v_pk_mul_f32 v[214:215], v[214:215], v[222:223]
    v_cvt_pk_bf16_f32 v208, v208, v209
    v_cvt_pk_bf16_f32 v209, v210, v211
    v_cvt_pk_bf16_f32 v210, v212, v213
    v_cvt_pk_bf16_f32 v211, v214, v215
    buffer_store_dwordx4 v[208:211], v10, s[20:23], s48 offen offset:0 sc1
    s_add_u32 s48, s48, 4096
    v_pk_mul_f32 v[224:225], v[224:225], v[102:103] clamp
    v_pk_mul_f32 v[226:227], v[226:227], v[102:103] clamp
    v_pk_mul_f32 v[228:229], v[228:229], v[102:103] clamp
    v_pk_mul_f32 v[230:231], v[230:231], v[102:103] clamp
    v_pk_mul_f32 v[224:225], v[224:225], v[232:233]
    v_pk_mul_f32 v[226:227], v[226:227], v[234:235]
    v_pk_mul_f32 v[228:229], v[228:229], v[236:237]
    v_pk_mul_f32 v[230:231], v[230:231], v[238:239]
    v_cvt_pk_bf16_f32 v224, v224, v225
    v_cvt_pk_bf16_f32 v225, v226, v227
    v_cvt_pk_bf16_f32 v226, v228, v229
    v_cvt_pk_bf16_f32 v227, v230, v231
    buffer_store_dwordx4 v[224:227], v10, s[20:23], s48 offen offset:0 sc1
    s_add_u32 s48, s48, 4096
    v_pk_mul_f32 v[240:241], v[240:241], v[102:103] clamp
    v_pk_mul_f32 v[242:243], v[242:243], v[102:103] clamp
    v_pk_mul_f32 v[244:245], v[244:245], v[102:103] clamp
    v_pk_mul_f32 v[246:247], v[246:247], v[102:103] clamp
    v_pk_mul_f32 v[240:241], v[240:241], v[248:249]
    v_pk_mul_f32 v[242:243], v[242:243], v[250:251]
    v_pk_mul_f32 v[244:245], v[244:245], v[252:253]
    v_pk_mul_f32 v[246:247], v[246:247], v[254:255]
    v_cvt_pk_bf16_f32 v240, v240, v241
    v_cvt_pk_bf16_f32 v241, v242, v243
    v_cvt_pk_bf16_f32 v242, v244, v245
    v_cvt_pk_bf16_f32 v243, v246, v247
    buffer_store_dwordx4 v[240:243], v10, s[20:23], s48 offen offset:0 sc1
    s_setprio 0
    s_waitcnt vmcnt(7)
    v_cmp_ne_u32 vcc, 0, v15
    s_cmp_eq_u64 vcc, -1
    s_cbranch_scc1 SPD_13
    s_mov_b32 s54, 50000
SPL_12:
    s_sleep 2
    buffer_load_dword v15, v13, s[20:23], 0 offen sc1
    s_waitcnt vmcnt(0)
    s_sub_u32 s54, s54, 1
    s_cbranch_scc1 SPD_13
    v_cmp_ne_u32 vcc, 0, v15
    s_cmp_eq_u64 vcc, -1
    s_cbranch_scc0 SPL_12
SPD_13:
    s_add_u32 s43, s43, 4096
    buffer_load_dwordx4 v[96:99], v10, s[28:31], s43 offen offset:0 sc1
    buffer_load_dwordx4 v[100:103], v10, s[28:31], s43 offen offset:1024 sc1
    s_add_u32 s43, s47, 3
    s_and_b32 s43, s43, 3
    s_mul_i32 s43, s43, 6144
    s_add_u32 s43, s43, s57
    s_add_u32 s43, s43, 4096
    buffer_load_dwordx4 v[104:107], v10, s[28:31], s43 offen offset:0 sc1
    buffer_load_dwordx4 v[108:111], v10, s[28:31], s43 offen offset:1024 sc1
    buffer_load_dwordx4 v[112:115], v10, s[28:31], s43 offen offset:2048 sc1
    buffer_load_dwordx4 v[116:119], v10, s[28:31], s43 offen offset:3072 sc1
    s_add_u32 s43, s43, 4096
    buffer_load_dwordx4 v[120:123], v10, s[28:31], s43 offen offset:0 sc1
    buffer_load_dwordx4 v[124:127], v10, s[28:31], s43 offen offset:1024 sc1
    s_add_u32 s43, s57, 28672
    buffer_load_dwordx4 v[128:131], v10, s[28:31], s43 offen offset:0 sc1
    buffer_load_dwordx4 v[132:135], v10, s[28:31], s43 offen offset:1024 sc1
    buffer_load_dwordx4 v[136:139], v10, s[28:31], s43 offen offset:2048 sc1
    buffer_load_dwordx4 v[140:143], v10, s[28:31], s43 offen offset:3072 sc1
    s_add_u32 s43, s57, 32768
    buffer_load_dwordx4 v[144:147], v10, s[28:31], s43 offen offset:0 sc1
    buffer_load_dwordx4 v[148:151], v10, s[28:31], s43 offen offset:1024 sc1
    buffer_load_dwordx4 v[152:155], v10, s[28:31], s43 offen offset:2048 sc1
    buffer_load_dwordx4 v[156:159], v10, s[28:31], s43 offen offset:3072 sc1
    s_lshl_b32 s48, s7, 1
    v_add_u32 v2, s48, v10
    v_add_u32 v3, 65536, v2
    v_add_u32 v4, 131072, v2
    s_and_b32 s50, s58, 7
    s_lshr_b32 s49, s58, 3
    s_mul_i32 s58, s49, 294912
    s_and_b32 s48, s3, 1
    s_mul_i32 s51, s48, 147456
    v_add_u32 v6, s51, v10
    s_xor_b32 s51, s51, 147456
    v_add_u32 v7, s51, v10
    s_lshl_b32 s51, s49, 1
    s_add_u32 s51, s51, s48
    s_lshl_b32 s51, s51, 5
    v_and_b32 v3, 31, v1
    v_add_u32 v3, s51, v3
    v_mul_u32_u24 v3, 896, v3
    v_lshrrev_b32 v4, 5, v1
    v_lshl_add_u32 v3, v4, 4, v3
    s_lshl_b32 s50, s50, 7
    s_bfe_u32 s51, s3, 0x10001
    s_lshl_b32 s51, s51, 6
    s_add_u32 s50, s50, s51
    s_lshr_b32 s51, s3, 2
    s_lshl_b32 s51, s51, 5
    s_add_u32 s50, s50, s51
    v_add_u32 v5, s50, v3
    buffer_load_dwordx4 v[12:15], v5, s[8:11], 0 offen
    s_waitcnt lgkmcnt(0)
    s_branch L_H
L_A:
    v_lshrrev_b32 v12, 3, v1
    s_lshl_b32 s48, s5, 7
    s_lshl_b32 s49, s3, 4
    s_add_u32 s48, s48, s49
    v_add_u32 v13, s48, v12
    v_mul_u32_u24 v13, 896, v13
    v_lshrrev_b32 v14, 4, v1
    v_and_b32 v15, 7, v1
    v_xor_b32 v6, v14, v15
    v_lshl_add_u32 v2, v6, 4, v13
    v_xor_b32 v6, 4, v6
    v_lshl_add_u32 v3, v6, 4, v13
    v_add_u32 v3, 6144, v3
    s_lshl_b32 s48, s3, 3
    v_add_u32 v13, s48, v12
    v_mul_u32_u24 v13, 2688, v13
    v_and_b32 v14, 1, v14
    v_lshlrev_b32 v14, 2, v14
    v_xor_b32 v14, v14, v15
    v_lshl_add_u32 v13, v14, 4, v13
    s_lshl_b32 s48, s4, 1
    s_add_u32 s48, s48, s6
    s_sub_u32 s57, s48, 2
    s_mul_i32 s48, s57, 112
    v_add_u32 v13, s48, v13
    v_mov_b32 v12, 0x40000000
    v_cmp_eq_u32 vcc, 7, v14
    s_nop 1
    v_cndmask_b32 v4, v13, v12, vcc
    s_lshr_b32 s48, s3, 2
    s_lshl_b32 s48, s48, 1
    s_and_b32 s49, s3, 1
    s_add_u32 s48, s48, s49
    s_and_b32 s49, s3, 2
    s_lshl_b32 s50, s49, 1
    s_add_u32 s50, s50, s48
    s_lshl_b32 s26, s50, 10
    s_lshl_b32 s48, s48, 4
    v_lshrrev_b32 v12, 2, v1
    v_add_u32 v12, s48, v12
    v_mul_u32_u24 v12, 3584, v12
    v_and_b32 v13, 3, v1
    v_xor_b32 v13, s49, v13
    v_lshl_add_u32 v12, v13, 4, v12
    s_mul_i32 s48, s4, 896
    s_lshl_b32 s49, s6, 6
    s_add_u32 s48, s48, s49
    s_add_u32 s48, s48, 640
    v_add_u32 v5, s48, v12
    s_mov_b32 s18, s54
    s_waitcnt lgkmcnt(0)
    buffer_load_dwordx4 v[96:99], v118, s[8:11], 0 offen
    s_lshl_b32 s51, s7, 1
    s_add_u32 m0, s51, 0
    s_lshl_b32 s51, s18, 7
    buffer_load_dwordx4 v2, s[8:11], s51 offen lds
    buffer_load_dwordx4 v3, s[8:11], s51 offen offset:1024 lds
    s_mul_i32 s52, s18, 172032
    s_add_u32 m0, s7, 15488
    s_nop 0
    buffer_load_dwordx4 v4, s[40:43], s52 offen offset:896 lds
    s_add_u32 m0, s7, 22784
    s_nop 0
    buffer_load_dwordx4 v4, s[40:43], s52 offen offset:1792 lds
    s_add_u32 m0, s7, 32768
    s_nop 0
    buffer_load_dwordx4 v4, s[40:43], s52 offen offset:0 lds
    s_add_u32 m0, s26, 40960
    s_mul_i32 s51, s18, 229376
    buffer_load_dwordx4 v5, s[12:15], s51 offen lds
    s_add_u32 s18, s18, 1
    s_cmp_eq_u32 s18, 7
    s_cselect_b32 s18, 0, s18
    s_lshl_b32 s48, s59, 7
    s_lshl_b32 s49, s3, 2
    s_add_u32 s48, s48, s49
    s_add_u32 s48, s48, 0x1020000
    v_mov_b32 v11, s48
    v_lshrrev_b32 v12, 5, v1
    v_bfe_u32 v13, v1, 2, 2
    v_and_b32 v14, 3, v1
    v_bfe_u32 v15, v1, 4, 1
    v_bfe_u32 v6, v1, 1, 3
    v_xor_b32 v6, v6, v12
    v_lshlrev_b32 v6, 4, v6
    v_and_b32 v7, 31, v1
    v_lshl_add_u32 v6, v7, 7, v6
    s_and_b32 s48, s3, 3
    s_lshl_b32 s49, s48, 12
    v_add_u32 v6, s49, v6
    v_xor_b32 v7, 32, v6
    v_xor_b32 v8, 64, v6
    v_xor_b32 v9, 96, v6
    s_lshr_b32 s49, s3, 2
    v_lshl_add_u32 v18, v12, 3, v13
    v_lshlrev_b32 v19, 3, v14
    v_lshl_add_u32 v17, v18, 6, v19
    v_lshl_add_u32 v17, v15, 12, v17
    v_xor_b32 v16, s49, v15
    v_lshl_add_u32 v17, v16, 5, v17
    v_lshl_add_u32 v19, v15, 5, v19
    v_lshrrev_b32 v16, 1, v13
    v_lshl_add_u32 v19, v16, 6, v19
    s_mul_i32 s50, s49, 56
    v_add_u32 v19, s50, v19
    v_and_b32 v19, 127, v19
    v_lshl_add_u32 v16, v18, 7, v19
    v_lshl_add_u32 v18, v12, 2, v13
    v_mul_u32_u24 v18, 56, v18
    v_lshl_add_u32 v18, v14, 3, v18
    v_lshl_add_u32 v18, v15, 5, v18
    s_mul_i32 s50, s49, 1568
    s_add_u32 s50, s50, 151552
    v_add_u32 v18, s50, v18
    s_lshl_b32 s50, s5, 2
    s_add_u32 s50, s50, s48
    s_mul_i32 s53, s50, 147456
    s_waitcnt vmcnt(6)
    v_lshlrev_b32 v108, 16, v96
    v_and_b32 v112, 0xffff0000, v96
    v_mul_f32 v109, v108, v108
    v_mul_f32 v113, v112, v112
    v_lshlrev_b32 v110, 16, v97
    v_and_b32 v111, 0xffff0000, v97
    v_add_f32 v108, v108, v110
    v_fmac_f32 v109, v110, v110
    v_add_f32 v112, v112, v111
    v_fmac_f32 v113, v111, v111
    v_lshlrev_b32 v110, 16, v98
    v_and_b32 v111, 0xffff0000, v98
    v_add_f32 v108, v108, v110
    v_fmac_f32 v109, v110, v110
    v_add_f32 v112, v112, v111
    v_fmac_f32 v113, v111, v111
    v_lshlrev_b32 v110, 16, v99
    v_and_b32 v111, 0xffff0000, v99
    v_add_f32 v108, v108, v110
    v_fmac_f32 v109, v110, v110
    v_add_f32 v112, v112, v111
    v_fmac_f32 v113, v111, v111
    v_add_f32 v108, v108, v112
    v_add_f32 v109, v109, v113
    s_nop 0
    v_add_f32_dpp v108, v108, v108 row_shr:1 row_mask:0xf bank_mask:0xf bound_ctrl:0
    v_add_f32_dpp v109, v109, v109 row_shr:1 row_mask:0xf bank_mask:0xf bound_ctrl:0
    s_nop 0
    v_add_f32_dpp v108, v108, v108 row_shr:2 row_mask:0xf bank_mask:0xf bound_ctrl:0
    v_add_f32_dpp v109, v109, v109 row_shr:2 row_mask:0xf bank_mask:0xf bound_ctrl:0
    s_nop 0
    v_add_f32_dpp v108, v108, v108 row_shr:4 row_mask:0xf bank_mask:0xf bound_ctrl:0
    v_add_f32_dpp v109, v109, v109 row_shr:4 row_mask:0xf bank_mask:0xf bound_ctrl:0
    s_nop 0
    v_add_f32_dpp v108, v108, v108 row_shr:8 row_mask:0xf bank_mask:0xf bound_ctrl:0
    v_add_f32_dpp v109, v109, v109 row_shr:8 row_mask:0xf bank_mask:0xf bound_ctrl:0
    s_nop 0
    v_add_f32_dpp v108, v108, v108 row_bcast:15 row_mask:0xa bank_mask:0xf
    v_add_f32_dpp v109, v109, v109 row_bcast:15 row_mask:0xa bank_mask:0xf
    s_nop 0
    v_add_f32_dpp v108, v108, v108 row_bcast:31 row_mask:0xc bank_mask:0xf
    v_add_f32_dpp v109, v109, v109 row_bcast:31 row_mask:0xc bank_mask:0xf
    v_mul_f32 v108, 0xbb124925, v108
    v_mul_f32 v109, 0x3b124925, v109
    v_fma_f32 v109, -v108, v108, v109
    v_cvt_pk_bf16_f32 v110, v108, v108
    v_max_f32 v109, 0, v109
    v_lshlrev_b32 v110, 16, v110
    v_add_f32 v109, 0x3727c5ac, v109
    v_sub_f32 v110, v108, v110
    v_rsq_f32 v96, v109
    v_cvt_pk_bf16_f32 v98, v108, v110
    v_rcp_f32 v97, v109
    v_mov_b32 v99, v98
    s_lshl_b32 s51, s7, 1
    s_add_u32 m0, s51, 49152
    s_lshl_b32 s51, s18, 7
    buffer_load_dwordx4 v2, s[8:11], s51 offen lds
    buffer_load_dwordx4 v3, s[8:11], s51 offen offset:1024 lds
    s_mul_i32 s52, s18, 172032
    s_add_u32 m0, s7, 64640
    s_nop 0
    buffer_load_dwordx4 v4, s[40:43], s52 offen offset:896 lds
    s_add_u32 m0, s7, 71936
    s_nop 0
    buffer_load_dwordx4 v4, s[40:43], s52 offen offset:1792 lds
    s_add_u32 m0, s7, 81920
    s_nop 0
    buffer_load_dwordx4 v4, s[40:43], s52 offen offset:0 lds
    s_add_u32 m0, s26, 90112
    s_mul_i32 s51, s18, 229376
    buffer_load_dwordx4 v5, s[12:15], s51 offen lds
    s_add_u32 s18, s18, 1
    s_cmp_eq_u32 s18, 7
    s_cselect_b32 s18, 0, s18
    s_waitcnt vmcnt(6) lgkmcnt(0)
    s_barrier
    ds_read_b128 v[120:123], v6
    ds_read_b64_tr_b16 v[124:125], v16 offset:16384
    ds_read_b64_tr_b16 v[126:127], v16 offset:16896
    ds_read_b64_tr_b16 v[128:129], v16 offset:24576
    ds_read_b64_tr_b16 v[130:131], v16 offset:25088
    ds_read_b64_tr_b16 v[132:133], v16 offset:32768
    ds_read_b64_tr_b16 v[134:135], v16 offset:33280
    ds_read_b64_tr_b16 v[136:137], v17 offset:40960
    ds_read_b64_tr_b16 v[138:139], v17 offset:41216
    s_lshl_b32 s51, s7, 1
    s_add_u32 m0, s51, 98304
    s_lshl_b32 s51, s18, 7
    buffer_load_dwordx4 v2, s[8:11], s51 offen lds
    buffer_load_dwordx4 v3, s[8:11], s51 offen offset:1024 lds
    s_mul_i32 s52, s18, 172032
    s_waitcnt lgkmcnt(6)
    v_mfma_f32_32x32x16_bf16 v[192:207], v[124:127], v[120:123], 0
    ds_read_b128 v[140:143], v7
    ds_read_b64_tr_b16 v[144:145], v16 offset:18432
    ds_read_b64_tr_b16 v[146:147], v16 offset:18944
    ds_read_b64_tr_b16 v[148:149], v16 offset:26624
    s_waitcnt lgkmcnt(8)
    v_mfma_f32_32x32x16_bf16 v[208:223], v[128:131], v[120:123], 0
    ds_read_b64_tr_b16 v[150:151], v16 offset:27136
    ds_read_b64_tr_b16 v[152:153], v16 offset:34816
    ds_read_b64_tr_b16 v[154:155], v16 offset:35328
    s_waitcnt lgkmcnt(9)
    v_mfma_f32_32x32x16_bf16 v[224:239], v[132:135], v[120:123], 0
    ds_read_b64_tr_b16 v[156:157], v17 offset:41984
    ds_read_b64_tr_b16 v[158:159], v17 offset:42240
    s_add_u32 m0, s7, 113792
    s_nop 0
    buffer_load_dwordx4 v4, s[40:43], s52 offen offset:896 lds
    s_waitcnt lgkmcnt(9)
    v_mfma_f32_32x32x16_bf16 v[240:255], v[136:139], v[120:123], 0
    s_add_u32 m0, s7, 121088
    s_nop 0
    buffer_load_dwordx4 v4, s[40:43], s52 offen offset:1792 lds
    s_waitcnt lgkmcnt(6)
    v_mfma_f32_32x32x16_bf16 v[192:207], v[144:147], v[140:143], v[192:207]
    ds_read_b128 v[120:123], v8
    ds_read_b64_tr_b16 v[124:125], v16 offset:20480
    ds_read_b64_tr_b16 v[126:127], v16 offset:20992
    ds_read_b64_tr_b16 v[128:129], v16 offset:28672
    s_waitcnt lgkmcnt(8)
    v_mfma_f32_32x32x16_bf16 v[208:223], v[148:151], v[140:143], v[208:223]
    ds_read_b64_tr_b16 v[130:131], v16 offset:29184
    ds_read_b64_tr_b16 v[132:133], v16 offset:36864
    ds_read_b64_tr_b16 v[134:135], v16 offset:37376
    s_waitcnt lgkmcnt(9)
    v_mfma_f32_32x32x16_bf16 v[224:239], v[152:155], v[140:143], v[224:239]
    ds_read_b64_tr_b16 v[136:137], v17 offset:43008
    ds_read_b64_tr_b16 v[138:139], v17 offset:43264
    s_add_u32 m0, s7, 131072
    s_nop 0
    buffer_load_dwordx4 v4, s[40:43], s52 offen offset:0 lds
    s_waitcnt lgkmcnt(9)
    v_mfma_f32_32x32x16_bf16 v[240:255], v[156:159], v[140:143], v[240:255]
    s_add_u32 m0, s26, 139264
    s_mul_i32 s51, s18, 229376
    buffer_load_dwordx4 v5, s[12:15], s51 offen lds
    s_add_u32 s18, s18, 1
    s_cmp_eq_u32 s18, 7
    s_cselect_b32 s18, 0, s18
    s_waitcnt lgkmcnt(6)
    v_mfma_f32_32x32x16_bf16 v[192:207], v[124:127], v[120:123], v[192:207]
    ds_read_b128 v[140:143], v9
    ds_read_b64_tr_b16 v[144:145], v16 offset:22528
    ds_read_b64_tr_b16 v[146:147], v16 offset:23040
    ds_read_b64_tr_b16 v[148:149], v16 offset:30720
    s_waitcnt lgkmcnt(8)
    v_mfma_f32_32x32x16_bf16 v[208:223], v[128:131], v[120:123], v[208:223]
    ds_read_b64_tr_b16 v[150:151], v16 offset:31232
    ds_read_b64_tr_b16 v[152:153], v16 offset:38912
    ds_read_b64_tr_b16 v[154:155], v16 offset:39424
    s_waitcnt lgkmcnt(9)
    v_mfma_f32_32x32x16_bf16 v[224:239], v[132:135], v[120:123], v[224:239]
    ds_read_b64_tr_b16 v[156:157], v17 offset:44032
    ds_read_b64_tr_b16 v[158:159], v17 offset:44288
    s_waitcnt lgkmcnt(9)
    v_mfma_f32_32x32x16_bf16 v[240:255], v[136:139], v[120:123], v[240:255]
    v_add_u32 v6, 49152, v6
    v_add_u32 v7, 49152, v7
    v_add_u32 v8, 49152, v8
    v_add_u32 v9, 49152, v9
    v_add_u32 v16, 49152, v16
    v_add_u32 v17, 49152, v17
    s_add_u32 m0, s7, 151552
    s_mul_i32 s51, s57, 3136
    s_add_u32 s51, s51, s7
    buffer_load_dwordx4 v10, s[44:47], s51 offen lds
    s_mov_b32 s45, s57
    s_cmp_lg_u32 s3, 7
    s_cbranch_scc1 SK_14
    v_and_b32 v14, 15, v1
    v_lshlrev_b32 v14, 2, v14
    buffer_load_dword v14, v14, s[36:39], 0 offen sc1
SK_14:
    s_waitcnt vmcnt(7) lgkmcnt(0)
    s_barrier
    v_mfma_f32_32x32x16_bf16 v[192:207], v[144:147], v[140:143], v[192:207]
    ds_read_b128 v[120:123], v6
    ds_read_b64_tr_b16 v[124:125], v16 offset:16384
    ds_read_b64_tr_b16 v[126:127], v16 offset:16896
    ds_read_b64_tr_b16 v[128:129], v16 offset:24576
    v_mfma_f32_32x32x16_bf16 v[208:223], v[148:151], v[140:143], v[208:223]
    ds_read_b64_tr_b16 v[130:131], v16 offset:25088
    ds_read_b64_tr_b16 v[132:133], v16 offset:32768
    ds_read_b64_tr_b16 v[134:135], v16 offset:33280
    v_mfma_f32_32x32x16_bf16 v[224:239], v[152:155], v[140:143], v[224:239]
    ds_read_b64_tr_b16 v[136:137], v17 offset:40960
    ds_read_b64_tr_b16 v[138:139], v17 offset:41216
    s_lshl_b32 s51, s7, 1
    s_add_u32 m0, s51, 0
    s_lshl_b32 s51, s18, 7
    buffer_load_dwordx4 v2, s[8:11], s51 offen lds
    v_mfma_f32_32x32x16_bf16 v[240:255], v[156:159], v[140:143], v[240:255]
    buffer_load_dwordx4 v3, s[8:11], s51 offen offset:1024 lds
    s_mul_i32 s52, s18, 172032
    s_waitcnt lgkmcnt(6)
    v_mfma_f32_32x32x16_bf16 v[192:207], v[124:127], v[120:123], v[192:207]
    ds_read_b128 v[140:143], v7
    ds_read_b64_tr_b16 v[144:145], v16 offset:18432
    ds_read_b64_tr_b16 v[146:147], v16 offset:18944
    ds_read_b64_tr_b16 v[148:149], v16 offset:26624
    s_waitcnt lgkmcnt(8)
    v_mfma_f32_32x32x16_bf16 v[208:223], v[128:131], v[120:123], v[208:223]
    ds_read_b64_tr_b16 v[150:151], v16 offset:27136
    ds_read_b64_tr_b16 v[152:153], v16 offset:34816
    ds_read_b64_tr_b16 v[154:155], v16 offset:35328
    s_waitcnt lgkmcnt(9)
    v_mfma_f32_32x32x16_bf16 v[224:239], v[132:135], v[120:123], v[224:239]
    ds_read_b64_tr_b16 v[156:157], v17 offset:41984
    ds_read_b64_tr_b16 v[158:159], v17 offset:42240
    s_add_u32 m0, s7, 15488
    s_nop 0
    buffer_load_dwordx4 v4, s[40:43], s52 offen offset:896 lds
    s_waitcnt lgkmcnt(9)
    v_mfma_f32_32x32x16_bf16 v[240:255], v[136:139], v[120:123], v[240:255]
    s_add_u32 m0, s7, 22784
    s_nop 0
    buffer_load_dwordx4 v4, s[40:43], s52 offen offset:1792 lds
    s_waitcnt lgkmcnt(6)
    v_mfma_f32_32x32x16_bf16 v[192:207], v[144:147], v[140:143], v[192:207]
    ds_read_b128 v[120:123], v8
    ds_read_b64_tr_b16 v[124:125], v16 offset:20480
    ds_read_b64_tr_b16 v[126:127], v16 offset:20992
    ds_read_b64_tr_b16 v[128:129], v16 offset:28672
    s_waitcnt lgkmcnt(8)
    v_mfma_f32_32x32x16_bf16 v[208:223], v[148:151], v[140:143], v[208:223]
    ds_read_b64_tr_b16 v[130:131], v16 offset:29184
    ds_read_b64_tr_b16 v[132:133], v16 offset:36864
    ds_read_b64_tr_b16 v[134:135], v16 offset:37376
    s_waitcnt lgkmcnt(9)
    v_mfma_f32_32x32x16_bf16 v[224:239], v[152:155], v[140:143], v[224:239]
    ds_read_b64_tr_b16 v[136:137], v17 offset:43008
    ds_read_b64_tr_b16 v[138:139], v17 offset:43264
    s_add_u32 m0, s7, 32768
    s_nop 0
    buffer_load_dwordx4 v4, s[40:43], s52 offen offset:0 lds
    s_waitcnt lgkmcnt(9)
    v_mfma_f32_32x32x16_bf16 v[240:255], v[156:159], v[140:143], v[240:255]
    s_add_u32 m0, s26, 40960
    s_mul_i32 s51, s18, 229376
    buffer_load_dwordx4 v5, s[12:15], s51 offen lds
    s_add_u32 s18, s18, 1
    s_cmp_eq_u32 s18, 7
    s_cselect_b32 s18, 0, s18
    s_waitcnt lgkmcnt(6)
    v_mfma_f32_32x32x16_bf16 v[192:207], v[124:127], v[120:123], v[192:207]
    ds_read_b128 v[140:143], v9
    ds_read_b64_tr_b16 v[144:145], v16 offset:22528
    ds_read_b64_tr_b16 v[146:147], v16 offset:23040
    ds_read_b64_tr_b16 v[148:149], v16 offset:30720
    s_waitcnt lgkmcnt(8)
    v_mfma_f32_32x32x16_bf16 v[208:223], v[128:131], v[120:123], v[208:223]
    ds_read_b64_tr_b16 v[150:151], v16 offset:31232
    ds_read_b64_tr_b16 v[152:153], v16 offset:38912
    ds_read_b64_tr_b16 v[154:155], v16 offset:39424
    s_waitcnt lgkmcnt(9)
    v_mfma_f32_32x32x16_bf16 v[224:239], v[132:135], v[120:123], v[224:239]
    ds_read_b64_tr_b16 v[156:157], v17 offset:44032
    ds_read_b64_tr_b16 v[158:159], v17 offset:44288
    s_waitcnt lgkmcnt(9)
    v_mfma_f32_32x32x16_bf16 v[240:255], v[136:139], v[120:123], v[240:255]
    v_add_u32 v6, 49152, v6
    v_add_u32 v7, 49152, v7
    v_add_u32 v8, 49152, v8
    v_add_u32 v9, 49152, v9
    v_add_u32 v16, 49152, v16
    v_add_u32 v17, 49152, v17
    s_cmp_lg_u32 s3, 7
    s_cbranch_scc1 SK_15
    s_waitcnt vmcnt(6)
    v_cmp_eq_u32 vcc, 1, v14
    s_cmp_eq_u64 vcc, -1
    s_cbranch_scc1 SPD_17
    s_mov_b32 s54, 50000
SPL_16:
    s_sleep 4
    v_and_b32 v14, 15, v1
    v_lshlrev_b32 v14, 2, v14
    buffer_load_dword v14, v14, s[36:39], 0 offen sc1
    s_waitcnt vmcnt(0)
    s_sub_u32 s54, s54, 1
    s_cbranch_scc1 SPD_17
    v_cmp_eq_u32 vcc, 1, v14
    s_cmp_eq_u64 vcc, -1
    s_cbranch_scc0 SPL_16
SPD_17:
SK_15:
    v_mov_b32 v164, -1
    v_mov_b32 v165, -1
    v_mov_b32 v166, -1
    v_mov_b32 v167, -1
    s_mul_i32 s51, s4, 28
    s_lshl1_add_u32 s51, s6, s51
    s_lshr_b32 s52, s3, 2
    s_add_u32 s51, s51, s52
    s_add_u32 s51, s51, 20
    s_lshl_b32 s51, s51, 10
    s_add_u32 s51, s51, s53
    buffer_store_dwordx4 v[164:167], v10, s[20:23], s51 offen sc1
    s_lshl1_add_u32 s52, s45, s52
    s_lshl_b32 s52, s52, 11
    s_add_u32 s52, s52, s53
    s_add_u32 s52, s52, 114688
    buffer_store_dwordx4 v[164:167], v10, s[20:23], s52 offen offset:0 sc1
    buffer_store_dwordx4 v[164:167], v10, s[20:23], s52 offen offset:1024 sc1
    s_waitcnt vmcnt(9) lgkmcnt(0)
    s_barrier
    v_mfma_f32_32x32x16_bf16 v[192:207], v[144:147], v[140:143], v[192:207]
    ds_read_b128 v[120:123], v6
    ds_read_b64_tr_b16 v[124:125], v16 offset:16384
    ds_read_b64_tr_b16 v[126:127], v16 offset:16896
    ds_read_b64_tr_b16 v[128:129], v16 offset:24576
    v_mfma_f32_32x32x16_bf16 v[208:223], v[148:151], v[140:143], v[208:223]
    ds_read_b64_tr_b16 v[130:131], v16 offset:25088
    ds_read_b64_tr_b16 v[132:133], v16 offset:32768
    ds_read_b64_tr_b16 v[134:135], v16 offset:33280
    v_mfma_f32_32x32x16_bf16 v[224:239], v[152:155], v[140:143], v[224:239]
    ds_read_b64_tr_b16 v[136:137], v17 offset:40960
    ds_read_b64_tr_b16 v[138:139], v17 offset:41216
    s_lshl_b32 s51, s7, 1
    s_add_u32 m0, s51, 49152
    s_lshl_b32 s51, s18, 7
    buffer_load_dwordx4 v2, s[8:11], s51 offen lds
    v_mfma_f32_32x32x16_bf16 v[240:255], v[156:159], v[140:143], v[240:255]
    buffer_load_dwordx4 v3, s[8:11], s51 offen offset:1024 lds
    s_mul_i32 s52, s18, 172032
    s_lshl_b32 s51, s59, 3
    s_add_u32 s51, s51, s3
    s_lshl_b32 s51, s51, 4
    s_add_u32 s51, s51, 0x1027c10
    s_mov_b32 exec_lo, 0
    s_mov_b32 exec_hi, 0x80000000
    buffer_store_dwordx4 v[96:99], v10, s[20:23], s51 offen sc1
    s_mov_b64 exec, -1
    s_waitcnt lgkmcnt(6)
    v_mfma_f32_32x32x16_bf16 v[192:207], v[124:127], v[120:123], v[192:207]
    ds_read_b128 v[140:143], v7
    ds_read_b64_tr_b16 v[144:145], v16 offset:18432
    ds_read_b64_tr_b16 v[146:147], v16 offset:18944
    ds_read_b64_tr_b16 v[148:149], v16 offset:26624
    s_waitcnt lgkmcnt(8)
    v_mfma_f32_32x32x16_bf16 v[208:223], v[128:131], v[120:123], v[208:223]
    ds_read_b64_tr_b16 v[150:151], v16 offset:27136
    ds_read_b64_tr_b16 v[152:153], v16 offset:34816
    ds_read_b64_tr_b16 v[154:155], v16 offset:35328
    s_waitcnt lgkmcnt(9)
    v_mfma_f32_32x32x16_bf16 v[224:239], v[132:135], v[120:123], v[224:239]
    ds_read_b64_tr_b16 v[156:157], v17 offset:41984
    ds_read_b64_tr_b16 v[158:159], v17 offset:42240
    s_add_u32 m0, s7, 64640
    s_nop 0
    buffer_load_dwordx4 v4, s[40:43], s52 offen offset:896 lds
    s_waitcnt lgkmcnt(9)
    v_mfma_f32_32x32x16_bf16 v[240:255], v[136:139], v[120:123], v[240:255]
    s_add_u32 m0, s7, 71936
    s_nop 0
    buffer_load_dwordx4 v4, s[40:43], s52 offen offset:1792 lds
    s_waitcnt lgkmcnt(6)
    v_mfma_f32_32x32x16_bf16 v[192:207], v[144:147], v[140:143], v[192:207]
    ds_read_b128 v[120:123], v8
    ds_read_b64_tr_b16 v[124:125], v16 offset:20480
    ds_read_b64_tr_b16 v[126:127], v16 offset:20992
    ds_read_b64_tr_b16 v[128:129], v16 offset:28672
    s_waitcnt lgkmcnt(8)
    v_mfma_f32_32x32x16_bf16 v[208:223], v[148:151], v[140:143], v[208:223]
    ds_read_b64_tr_b16 v[130:131], v16 offset:29184
    ds_read_b64_tr_b16 v[132:133], v16 offset:36864
    ds_read_b64_tr_b16 v[134:135], v16 offset:37376
    s_waitcnt lgkmcnt(9)
    v_mfma_f32_32x32x16_bf16 v[224:239], v[152:155], v[140:143], v[224:239]
    ds_read_b64_tr_b16 v[136:137], v17 offset:43008
    ds_read_b64_tr_b16 v[138:139], v17 offset:43264
    s_add_u32 m0, s7, 81920
    s_nop 0
    buffer_load_dwordx4 v4, s[40:43], s52 offen offset:0 lds
    s_waitcnt lgkmcnt(9)
    v_mfma_f32_32x32x16_bf16 v[240:255], v[156:159], v[140:143], v[240:255]
    s_add_u32 m0, s26, 90112
    s_mul_i32 s51, s18, 229376
    buffer_load_dwordx4 v5, s[12:15], s51 offen lds
    s_add_u32 s18, s18, 1
    s_cmp_eq_u32 s18, 7
    s_cselect_b32 s18, 0, s18
    ds_read_b64_tr_b16 v[20:21], v18 offset:0
    ds_read_b64_tr_b16 v[22:23], v18 offset:448
    ds_read_b64_tr_b16 v[24:25], v18 offset:896
    ds_read_b64_tr_b16 v[26:27], v18 offset:1344
    v_mov_b32 v28, 0x3f803f80
    v_mov_b32 v29, 0x3f803f80
    v_mov_b32 v30, 0x3f803f80
    v_mov_b32 v31, 0x3f803f80
    v_mov_b32 v32, 0x3f803f80
    s_waitcnt lgkmcnt(10)
    v_mfma_f32_32x32x16_bf16 v[192:207], v[124:127], v[120:123], v[192:207]
    ds_read_b128 v[140:143], v9
    ds_read_b64_tr_b16 v[144:145], v16 offset:22528
    ds_read_b64_tr_b16 v[146:147], v16 offset:23040
    ds_read_b64_tr_b16 v[148:149], v16 offset:30720
    v_mov_b32 v33, 0x3f803f80
    s_mov_b32 exec_lo, 0
    s_waitcnt lgkmcnt(4)
    v_mov_b32 v26, 0
    v_mov_b32 v27, 0
    v_mov_b32 v32, 0
    v_mov_b32 v33, 0
    s_mov_b32 exec_lo, 0xf0000000
    s_mov_b32 exec_hi, 0xf0000000
    v_mov_b32 v20, 0
    v_mov_b32 v21, 0
    v_mov_b32 v22, 0
    v_mov_b32 v23, 0
    v_mov_b32 v24, 0
    v_mov_b32 v25, 0
    v_mov_b32 v26, 0
    v_mov_b32 v27, 0
    s_mov_b64 exec, -1
    v_mfma_f32_32x32x16_bf16 v[208:223], v[128:131], v[120:123], v[208:223]
    ds_read_b64_tr_b16 v[150:151], v16 offset:31232
    ds_read_b64_tr_b16 v[152:153], v16 offset:38912
    ds_read_b64_tr_b16 v[154:155], v16 offset:39424
    v_and_b32 v160, 31, v1
    s_and_b32 s48, s3, 3
    s_lshl_b32 s48, s48, 5
    v_lshrrev_b32 v161, 2, v160
    v_add_u32 v160, s48, v160
    v_mfma_f32_32x32x16_bf16 v[224:239], v[132:135], v[120:123], v[224:239]
    ds_read_b64_tr_b16 v[156:157], v17 offset:44032
    ds_read_b64_tr_b16 v[158:159], v17 offset:44288
    v_mul_u32_u24 v160, 320, v160
    v_lshrrev_b32 v162, 5, v1
    v_xor_b32 v161, v161, v162
    s_lshr_b32 s48, s3, 2
    s_mul_i32 s48, s48, 40960
    v_mfma_f32_32x32x16_bf16 v[240:255], v[136:139], v[120:123], v[240:255]
    v_add_u32 v6, -98304, v6
    v_add_u32 v7, -98304, v7
    v_add_u32 v8, -98304, v8
    v_add_u32 v9, -98304, v9
    v_add_u32 v16, -98304, v16
    v_add_u32 v17, -98304, v17
    s_add_u32 s48, s48, 49152
    v_lshl_add_u32 v160, v161, 3, v160
    v_add_u32 v34, s48, v160
    v_xor_b32 v35, 16, v34
    v_xor_b32 v36, 32, v34
    s_waitcnt vmcnt(10) lgkmcnt(0)
    s_barrier
    v_mfma_f32_32x32x16_bf16 v[192:207], v[144:147], v[140:143], v[192:207]
    ds_read_b128 v[120:123], v6
    ds_read_b64_tr_b16 v[124:125], v16 offset:16384
    ds_read_b64_tr_b16 v[126:127], v16 offset:16896
    ds_read_b64_tr_b16 v[128:129], v16 offset:24576
    v_xor_b32 v37, 48, v34
    v_lshrrev_b32 v160, 5, v1
    v_bfe_u32 v161, v1, 2, 2
    v_lshl_add_u32 v161, v160, 3, v161
    v_mul_u32_u24 v38, 320, v161
    v_mfma_f32_32x32x16_bf16 v[208:223], v[148:151], v[140:143], v[208:223]
    ds_read_b64_tr_b16 v[130:131], v16 offset:25088
    ds_read_b64_tr_b16 v[132:133], v16 offset:32768
    ds_read_b64_tr_b16 v[134:135], v16 offset:33280
    v_and_b32 v161, 3, v1
    v_bfe_u32 v162, v1, 4, 1
    v_lshl_add_u32 v161, v162, 2, v161
    v_lshlrev_b32 v160, 1, v160
    v_xor_b32 v161, v161, v160
    v_mfma_f32_32x32x16_bf16 v[224:239], v[152:155], v[140:143], v[224:239]
    ds_read_b64_tr_b16 v[136:137], v17 offset:40960
    ds_read_b64_tr_b16 v[138:139], v17 offset:41216
    s_lshl_b32 s51, s7, 1
    s_add_u32 m0, s51, 98304
    s_lshl_b32 s51, s18, 7
    buffer_load_dwordx4 v2, s[8:11], s51 offen lds
    v_lshl_add_u32 v38, v161, 3, v38
    s_lshr_b32 s48, s3, 1
    s_mul_i32 s48, s48, 40960
    s_and_b32 s49, s3, 1
    s_lshl_b32 s49, s49, 6
    v_mfma_f32_32x32x16_bf16 v[240:255], v[156:159], v[140:143], v[240:255]
    buffer_load_dwordx4 v3, s[8:11], s51 offen offset:1024 lds
    s_mul_i32 s52, s18, 172032
    s_add_u32 s48, s48, s49
    s_add_u32 s48, s48, 49152
    v_add_u32 v38, s48, v38
    v_xor_b32 v39, 8, v38
    v_add_u32 v39, 1280, v39
    s_waitcnt lgkmcnt(6)
    v_mfma_f32_32x32x16_bf16 v[192:207], v[124:127], v[120:123], v[192:207]
    ds_read_b128 v[140:143], v7
    ds_read_b64_tr_b16 v[144:145], v16 offset:18432
    ds_read_b64_tr_b16 v[146:147], v16 offset:18944
    ds_read_b64_tr_b16 v[148:149], v16 offset:26624
    v_xor_b32 v118, 32, v38
    v_xor_b32 v119, 32, v39
    s_lshr_b32 s48, s2, 3
    s_mul_i32 s49, s48, 37
    s_lshr_b32 s49, s49, 8
    s_waitcnt lgkmcnt(8)
    v_mfma_f32_32x32x16_bf16 v[208:223], v[128:131], v[120:123], v[208:223]
    ds_read_b64_tr_b16 v[150:151], v16 offset:27136
    ds_read_b64_tr_b16 v[152:153], v16 offset:34816
    ds_read_b64_tr_b16 v[154:155], v16 offset:35328
    s_mov_b32 s47, s49
    s_mul_i32 s50, s49, 7
    s_sub_u32 s50, s48, s50
    s_and_b32 s48, s2, 7
    s_lshl_b32 s48, s48, 2
    s_waitcnt lgkmcnt(9)
    v_mfma_f32_32x32x16_bf16 v[224:239], v[132:135], v[120:123], v[224:239]
    ds_read_b64_tr_b16 v[156:157], v17 offset:41984
    ds_read_b64_tr_b16 v[158:159], v17 offset:42240
    s_add_u32 m0, s7, 113792
    s_nop 0
    buffer_load_dwordx4 v4, s[40:43], s52 offen offset:896 lds
    s_add_u32 s48, s48, s49
    s_lshl_b32 s58, s48, 3
    s_add_u32 s58, s58, s50
    s_lshl_b32 s50, s50, 3
    s_add_u32 s50, s50, s3
    s_waitcnt lgkmcnt(9)
    v_mfma_f32_32x32x16_bf16 v[240:255], v[136:139], v[120:123], v[240:255]
    s_add_u32 m0, s7, 121088
    s_nop 0
    buffer_load_dwordx4 v4, s[40:43], s52 offen offset:1792 lds
    s_mul_i32 s57, s50, 36864
    s_add_u32 s57, s57, 0xa00000
    s_lshl_b32 s50, s50, 7
    s_add_u32 s50, s50, 0x103a000
    v_min_u32 v19, 17, v1
    s_waitcnt lgkmcnt(6)
    v_mfma_f32_32x32x16_bf16 v[192:207], v[144:147], v[140:143], v[192:207]
    ds_read_b128 v[120:123], v8
    ds_read_b64_tr_b16 v[124:125], v16 offset:20480
    ds_read_b64_tr_b16 v[126:127], v16 offset:20992
    ds_read_b64_tr_b16 v[128:129], v16 offset:28672
    v_lshl_add_u32 v19, v19, 2, s50
    s_lshr_b32 s48, s3, 1
    s_and_b32 s49, s3, 1
    s_mul_i32 s48, s48, 28
    s_mul_i32 s50, s49, 12
    s_waitcnt lgkmcnt(8)
    v_mfma_f32_32x32x16_bf16 v[208:223], v[148:151], v[140:143], v[208:223]
    ds_read_b64_tr_b16 v[130:131], v16 offset:29184
    ds_read_b64_tr_b16 v[132:133], v16 offset:36864
    ds_read_b64_tr_b16 v[134:135], v16 offset:37376
    s_add_u32 s55, s48, s50
    s_lshl_b32 s50, s49, 1
    s_add_u32 s56, s48, s50
    s_add_u32 s56, s56, 24
    s_waitcnt lgkmcnt(9)
    v_mfma_f32_32x32x16_bf16 v[224:239], v[152:155], v[140:143], v[224:239]
    ds_read_b64_tr_b16 v[136:137], v17 offset:43008
    ds_read_b64_tr_b16 v[138:139], v17 offset:43264
    s_add_u32 m0, s7, 131072
    s_nop 0
    buffer_load_dwordx4 v4, s[40:43], s52 offen offset:0 lds
    s_waitcnt lgkmcnt(9)
    v_mfma_f32_32x32x16_bf16 v[240:255], v[156:159], v[140:143], v[240:255]
    s_add_u32 m0, s26, 139264
    s_mul_i32 s51, s18, 229376
    buffer_load_dwordx4 v5, s[12:15], s51 offen lds
    s_add_u32 s18, s18, 1
    s_cmp_eq_u32 s18, 7
    s_cselect_b32 s18, 0, s18
    s_waitcnt lgkmcnt(6)
    v_mfma_f32_32x32x16_bf16 v[192:207], v[124:127], v[120:123], v[192:207]
    ds_read_b128 v[140:143], v9
    ds_read_b64_tr_b16 v[144:145], v16 offset:22528
    ds_read_b64_tr_b16 v[146:147], v16 offset:23040
    ds_read_b64_tr_b16 v[148:149], v16 offset:30720
    s_waitcnt lgkmcnt(8)
    v_mfma_f32_32x32x16_bf16 v[208:223], v[128:131], v[120:123], v[208:223]
    ds_read_b64_tr_b16 v[150:151], v16 offset:31232
    ds_read_b64_tr_b16 v[152:153], v16 offset:38912
    ds_read_b64_tr_b16 v[154:155], v16 offset:39424
    s_waitcnt lgkmcnt(9)
    v_mfma_f32_32x32x16_bf16 v[224:239], v[132:135], v[120:123], v[224:239]
    ds_read_b64_tr_b16 v[156:157], v17 offset:44032
    ds_read_b64_tr_b16 v[158:159], v17 offset:44288
    s_waitcnt lgkmcnt(9)
    v_mfma_f32_32x32x16_bf16 v[240:255], v[136:139], v[120:123], v[240:255]
    v_add_u32 v6, 49152, v6
    v_add_u32 v7, 49152, v7
    v_add_u32 v8, 49152, v8
    v_add_u32 v9, 49152, v9
    v_add_u32 v16, 49152, v16
    v_add_u32 v17, 49152, v17
    s_waitcnt vmcnt(13)
    v_mov_b32 v163, 1
    s_mov_b64 exec, 1
    buffer_store_dword v163, v11, s[20:23], 0 offen offset:0 sc1
    s_mov_b64 exec, -1
    s_waitcnt vmcnt(7) lgkmcnt(0)
    s_barrier
    v_mfma_f32_32x32x16_bf16 v[192:207], v[144:147], v[140:143], v[192:207]
    ds_read_b128 v[120:123], v6
    ds_read_b64_tr_b16 v[124:125], v16 offset:16384
    ds_read_b64_tr_b16 v[126:127], v16 offset:16896
    ds_read_b64_tr_b16 v[128:129], v16 offset:24576
    v_mfma_f32_32x32x16_bf16 v[208:223], v[148:151], v[140:143], v[208:223]
    ds_read_b64_tr_b16 v[130:131], v16 offset:25088
    ds_read_b64_tr_b16 v[132:133], v16 offset:32768
    ds_read_b64_tr_b16 v[134:135], v16 offset:33280
    v_mfma_f32_32x32x16_bf16 v[224:239], v[152:155], v[140:143], v[224:239]
    ds_read_b64_tr_b16 v[136:137], v17 offset:40960
    ds_read_b64_tr_b16 v[138:139], v17 offset:41216
    s_lshl_b32 s51, s7, 1
    s_add_u32 m0, s51, 0
    s_lshl_b32 s51, s18, 7
    buffer_load_dwordx4 v2, s[8:11], s51 offen lds
    v_mfma_f32_32x32x16_bf16 v[240:255], v[156:159], v[140:143], v[240:255]
    buffer_load_dwordx4 v3, s[8:11], s51 offen offset:1024 lds
    s_mul_i32 s52, s18, 172032
    s_waitcnt lgkmcnt(6)
    v_mfma_f32_32x32x16_bf16 v[192:207], v[124:127], v[120:123], v[192:207]
    ds_read_b128 v[140:143], v7
    ds_read_b64_tr_b16 v[144:145], v16 offset:18432
    ds_read_b64_tr_b16 v[146:147], v16 offset:18944
    ds_read_b64_tr_b16 v[148:149], v16 offset:26624
    s_waitcnt lgkmcnt(8)
    v_mfma_f32_32x32x16_bf16 v[208:223], v[128:131], v[120:123], v[208:223]
    ds_read_b64_tr_b16 v[150:151], v16 offset:27136
    ds_read_b64_tr_b16 v[152:153], v16 offset:34816
    ds_read_b64_tr_b16 v[154:155], v16 offset:35328
    s_waitcnt lgkmcnt(9)
    v_mfma_f32_32x32x16_bf16 v[224:239], v[132:135], v[120:123], v[224:239]
    ds_read_b64_tr_b16 v[156:157], v17 offset:41984
    ds_read_b64_tr_b16 v[158:159], v17 offset:42240
    s_add_u32 m0, s7, 15488
    s_nop 0
    buffer_load_dwordx4 v4, s[40:43], s52 offen offset:896 lds
    s_waitcnt lgkmcnt(9)
    v_mfma_f32_32x32x16_bf16 v[240:255], v[136:139], v[120:123], v[240:255]
    s_add_u32 m0, s7, 22784
    s_nop 0
    buffer_load_dwordx4 v4, s[40:43], s52 offen offset:1792 lds
    s_waitcnt lgkmcnt(6)
    v_mfma_f32_32x32x16_bf16 v[192:207], v[144:147], v[140:143], v[192:207]
    ds_read_b128 v[120:123], v8
    ds_read_b64_tr_b16 v[124:125], v16 offset:20480
    ds_read_b64_tr_b16 v[126:127], v16 offset:20992
    ds_read_b64_tr_b16 v[128:129], v16 offset:28672
    s_waitcnt lgkmcnt(8)
    v_mfma_f32_32x32x16_bf16 v[208:223], v[148:151], v[140:143], v[208:223]
    ds_read_b64_tr_b16 v[130:131], v16 offset:29184
    ds_read_b64_tr_b16 v[132:133], v16 offset:36864
    ds_read_b64_tr_b16 v[134:135], v16 offset:37376
    s_waitcnt lgkmcnt(9)
    v_mfma_f32_32x32x16_bf16 v[224:239], v[152:155], v[140:143], v[224:239]
    ds_read_b64_tr_b16 v[136:137], v17 offset:43008
    ds_read_b64_tr_b16 v[138:139], v17 offset:43264
    s_add_u32 m0, s7, 32768
    s_nop 0
    buffer_load_dwordx4 v4, s[40:43], s52 offen offset:0 lds
    s_waitcnt lgkmcnt(9)
    v_mfma_f32_32x32x16_bf16 v[240:255], v[156:159], v[140:143], v[240:255]
    s_add_u32 m0, s26, 40960
    s_mul_i32 s51, s18, 229376
    buffer_load_dwordx4 v5, s[12:15], s51 offen lds
    s_add_u32 s18, s18, 1
    s_cmp_eq_u32 s18, 7
    s_cselect_b32 s18, 0, s18
    s_waitcnt lgkmcnt(6)
    v_mfma_f32_32x32x16_bf16 v[192:207], v[124:127], v[120:123], v[192:207]
    ds_read_b128 v[140:143], v9
    ds_read_b64_tr_b16 v[144:145], v16 offset:22528
    ds_read_b64_tr_b16 v[146:147], v16 offset:23040
    ds_read_b64_tr_b16 v[148:149], v16 offset:30720
    s_waitcnt lgkmcnt(8)
    v_mfma_f32_32x32x16_bf16 v[208:223], v[128:131], v[120:123], v[208:223]
    ds_read_b64_tr_b16 v[150:151], v16 offset:31232
    ds_read_b64_tr_b16 v[152:153], v16 offset:38912
    ds_read_b64_tr_b16 v[154:155], v16 offset:39424
    s_waitcnt lgkmcnt(9)
    v_mfma_f32_32x32x16_bf16 v[224:239], v[132:135], v[120:123], v[224:239]
    ds_read_b64_tr_b16 v[156:157], v17 offset:44032
    ds_read_b64_tr_b16 v[158:159], v17 offset:44288
    s_waitcnt lgkmcnt(9)
    v_mfma_f32_32x32x16_bf16 v[240:255], v[136:139], v[120:123], v[240:255]
    v_add_u32 v6, 49152, v6
    v_add_u32 v7, 49152, v7
    v_add_u32 v8, 49152, v8
    v_add_u32 v9, 49152, v9
    v_add_u32 v16, 49152, v16
    v_add_u32 v17, 49152, v17
    s_waitcnt vmcnt(7) lgkmcnt(0)
    s_barrier
    v_mfma_f32_32x32x16_bf16 v[192:207], v[144:147], v[140:143], v[192:207]
    ds_read_b128 v[120:123], v6
    ds_read_b64_tr_b16 v[124:125], v16 offset:16384
    ds_read_b64_tr_b16 v[126:127], v16 offset:16896
    ds_read_b64_tr_b16 v[128:129], v16 offset:24576
    v_mfma_f32_32x32x16_bf16 v[208:223], v[148:151], v[140:143], v[208:223]
    ds_read_b64_tr_b16 v[130:131], v16 offset:25088
    ds_read_b64_tr_b16 v[132:133], v16 offset:32768
    ds_read_b64_tr_b16 v[134:135], v16 offset:33280
    v_mfma_f32_32x32x16_bf16 v[224:239], v[152:155], v[140:143], v[224:239]
    ds_read_b64_tr_b16 v[136:137], v17 offset:40960
    ds_read_b64_tr_b16 v[138:139], v17 offset:41216
    v_mfma_f32_32x32x16_bf16 v[240:255], v[156:159], v[140:143], v[240:255]
    buffer_load_dword v18, v19, s[20:23], 0 offen sc1
    s_waitcnt lgkmcnt(6)
    v_mfma_f32_32x32x16_bf16 v[192:207], v[124:127], v[120:123], v[192:207]
    ds_read_b128 v[140:143], v7
    ds_read_b64_tr_b16 v[144:145], v16 offset:18432
    ds_read_b64_tr_b16 v[146:147], v16 offset:18944
    ds_read_b64_tr_b16 v[148:149], v16 offset:26624
    s_waitcnt lgkmcnt(8)
    v_mfma_f32_32x32x16_bf16 v[208:223], v[128:131], v[120:123], v[208:223]
    ds_read_b64_tr_b16 v[150:151], v16 offset:27136
    ds_read_b64_tr_b16 v[152:153], v16 offset:34816
    ds_read_b64_tr_b16 v[154:155], v16 offset:35328
    s_waitcnt lgkmcnt(9)
    v_mfma_f32_32x32x16_bf16 v[224:239], v[132:135], v[120:123], v[224:239]
    ds_read_b64_tr_b16 v[156:157], v17 offset:41984
    ds_read_b64_tr_b16 v[158:159], v17 offset:42240
    s_waitcnt lgkmcnt(9)
    v_mfma_f32_32x32x16_bf16 v[240:255], v[136:139], v[120:123], v[240:255]
    s_waitcnt lgkmcnt(6)
    v_mfma_f32_32x32x16_bf16 v[192:207], v[144:147], v[140:143], v[192:207]
    ds_read_b128 v[120:123], v8
    ds_read_b64_tr_b16 v[124:125], v16 offset:20480
    ds_read_b64_tr_b16 v[126:127], v16 offset:20992
    ds_read_b64_tr_b16 v[128:129], v16 offset:28672
    s_waitcnt lgkmcnt(8)
    v_mfma_f32_32x32x16_bf16 v[208:223], v[148:151], v[140:143], v[208:223]
    ds_read_b64_tr_b16 v[130:131], v16 offset:29184
    ds_read_b64_tr_b16 v[132:133], v16 offset:36864
    ds_read_b64_tr_b16 v[134:135], v16 offset:37376
    v_and_b32 v160, 31, v1
    v_lshlrev_b32 v161, 4, v160
    s_lshl_b32 s48, s5, 2
    s_and_b32 s49, s3, 3
    s_add_u32 s48, s48, s49
    s_lshl_b32 s48, s48, 9
    s_add_u32 s48, s48, 0x1028000
    buffer_load_dwordx4 v[96:99], v161, s[20:23], s48 offen sc1
    v_lshlrev_b32 v161, 3, v1
    v_mov_b32 v160, 0x40000000
    v_cmp_gt_u32 vcc, 28, v1
    s_nop 1
    v_cndmask_b32 v161, v160, v161, vcc
    s_lshr_b32 s49, s3, 2
    s_lshl_b32 s48, s45, 1
    s_add_u32 s48, s48, s49
    s_mul_i32 s48, s48, 224
    s_add_u32 s48, s48, 0x1037000
    s_add_u32 s50, s48, 3584
    buffer_load_dwordx2 v[102:103], v161, s[20:23], s50 offen sc1
    buffer_load_dwordx2 v[106:107], v161, s[20:23], s50 offen offset:3584 sc1
    buffer_load_dwordx2 v[110:111], v161, s[20:23], s48 offen sc1
    v_and_b32 v161, 15, v1
    v_lshlrev_b32 v161, 3, v161
    v_lshrrev_b32 v160, 4, v1
    v_mul_u32_u24 v14, 14336, v160
    v_add_u32 v161, v161, v14
    v_lshrrev_b32 v160, 1, v160
    v_lshl_add_u32 v161, v160, 30, v161
    s_mul_i32 s48, s4, 28
    s_lshl_b32 s50, s6, 1
    s_add_u32 s48, s48, s50
    s_add_u32 s48, s48, s49
    s_add_u32 s48, s48, 20
    s_lshl_b32 s44, s48, 10
    s_add_u32 s44, s44, s53
    s_lshl_b32 s48, s48, 7
    s_add_u32 s48, s48, 0x1030000
    buffer_load_dwordx2 v[114:115], v161, s[20:23], s48 offen sc1
    s_waitcnt lgkmcnt(9)
    v_mfma_f32_32x32x16_bf16 v[224:239], v[152:155], v[140:143], v[224:239]
    ds_read_b64_tr_b16 v[136:137], v17 offset:43008
    ds_read_b64_tr_b16 v[138:139], v17 offset:43264
    s_waitcnt lgkmcnt(9)
    v_mfma_f32_32x32x16_bf16 v[240:255], v[156:159], v[140:143], v[240:255]
    s_waitcnt lgkmcnt(6)
    v_mfma_f32_32x32x16_bf16 v[192:207], v[124:127], v[120:123], v[192:207]
    ds_read_b128 v[140:143], v9
    ds_read_b64_tr_b16 v[144:145], v16 offset:22528
    ds_read_b64_tr_b16 v[146:147], v16 offset:23040
    ds_read_b64_tr_b16 v[148:149], v16 offset:30720
    s_waitcnt vmcnt(5)
    v_cmp_ne_u32 vcc, 0, v18
    s_cmp_eq_u64 vcc, -1
    s_cselect_b32 s30, 0x10000000, 0
    s_cmp_ge_u32 s2, 224
    s_cselect_b32 s30, 0, s30
    s_waitcnt lgkmcnt(8)
    v_mfma_f32_32x32x16_bf16 v[208:223], v[128:131], v[120:123], v[208:223]
    ds_read_b64_tr_b16 v[150:151], v16 offset:31232
    ds_read_b64_tr_b16 v[152:153], v16 offset:38912
    ds_read_b64_tr_b16 v[154:155], v16 offset:39424
    s_add_u32 s43, s47, 0
    s_and_b32 s43, s43, 3
    s_mul_i32 s43, s43, 6144
    s_add_u32 s43, s43, s57
    s_add_u32 s43, s43, 4096
    buffer_load_dwordx4 v[40:43], v10, s[28:31], s43 offen offset:2048 sc1
    s_waitcnt lgkmcnt(9)
    v_mfma_f32_32x32x16_bf16 v[224:239], v[132:135], v[120:123], v[224:239]
    ds_read_b64_tr_b16 v[156:157], v17 offset:44032
    ds_read_b64_tr_b16 v[158:159], v17 offset:44288
    buffer_load_dwordx4 v[44:47], v10, s[28:31], s43 offen offset:3072 sc1
    s_waitcnt lgkmcnt(9)
    v_mfma_f32_32x32x16_bf16 v[240:255], v[136:139], v[120:123], v[240:255]
    v_add_u32 v6, -98304, v6
    v_add_u32 v7, -98304, v7
    v_add_u32 v8, -98304, v8
    v_add_u32 v9, -98304, v9
    v_add_u32 v16, -98304, v16
    v_add_u32 v17, -98304, v17
    s_add_u32 s43, s43, 4096
    buffer_load_dwordx4 v[48:51], v10, s[28:31], s43 offen offset:0 sc1
    s_waitcnt lgkmcnt(0)
    s_barrier
    v_mfma_f32_32x32x16_bf16 v[192:207], v[144:147], v[140:143], v[192:207]
    ds_read_b128 v[120:123], v6
    ds_read_b64_tr_b16 v[124:125], v16 offset:16384
    ds_read_b64_tr_b16 v[126:127], v16 offset:16896
    ds_read_b64_tr_b16 v[128:129], v16 offset:24576
    v_mfma_f32_32x32x16_bf16 v[208:223], v[148:151], v[140:143], v[208:223]
    ds_read_b64_tr_b16 v[130:131], v16 offset:25088
    ds_read_b64_tr_b16 v[132:133], v16 offset:32768
    ds_read_b64_tr_b16 v[134:135], v16 offset:33280
    buffer_load_dwordx4 v[52:55], v10, s[28:31], s43 offen offset:1024 sc1
    v_mfma_f32_32x32x16_bf16 v[224:239], v[152:155], v[140:143], v[224:239]
    ds_read_b64_tr_b16 v[136:137], v17 offset:40960
    ds_read_b64_tr_b16 v[138:139], v17 offset:41216
    s_add_u32 s43, s47, 1
    s_and_b32 s43, s43, 3
    s_mul_i32 s43, s43, 6144
    s_add_u32 s43, s43, s57
    s_add_u32 s43, s43, 4096
    buffer_load_dwordx4 v[56:59], v10, s[28:31], s43 offen offset:0 sc1
    v_mfma_f32_32x32x16_bf16 v[240:255], v[156:159], v[140:143], v[240:255]
    buffer_load_dwordx4 v[60:63], v10, s[28:31], s43 offen offset:1024 sc1
    s_waitcnt lgkmcnt(6)
    v_mfma_f32_32x32x16_bf16 v[192:207], v[124:127], v[120:123], v[192:207]
    ds_read_b128 v[140:143], v7
    ds_read_b64_tr_b16 v[144:145], v16 offset:18432
    ds_read_b64_tr_b16 v[146:147], v16 offset:18944
    ds_read_b64_tr_b16 v[148:149], v16 offset:26624
    s_waitcnt lgkmcnt(8)
    v_mfma_f32_32x32x16_bf16 v[208:223], v[128:131], v[120:123], v[208:223]
    ds_read_b64_tr_b16 v[150:151], v16 offset:27136
    ds_read_b64_tr_b16 v[152:153], v16 offset:34816
    ds_read_b64_tr_b16 v[154:155], v16 offset:35328
    buffer_load_dwordx4 v[64:67], v10, s[28:31], s43 offen offset:2048 sc1
    s_waitcnt lgkmcnt(9)
    v_mfma_f32_32x32x16_bf16 v[224:239], v[132:135], v[120:123], v[224:239]
    ds_read_b64_tr_b16 v[156:157], v17 offset:41984
    ds_read_b64_tr_b16 v[158:159], v17 offset:42240
    buffer_load_dwordx4 v[68:71], v10, s[28:31], s43 offen offset:3072 sc1
    s_waitcnt lgkmcnt(9)
    v_mfma_f32_32x32x16_bf16 v[240:255], v[136:139], v[120:123], v[240:255]
    s_add_u32 s43, s43, 4096
    buffer_load_dwordx4 v[72:75], v10, s[28:31], s43 offen offset:0 sc1
    s_waitcnt lgkmcnt(6)
    v_mfma_f32_32x32x16_bf16 v[192:207], v[144:147], v[140:143], v[192:207]
    ds_read_b128 v[120:123], v8
    ds_read_b64_tr_b16 v[124:125], v16 offset:20480
    ds_read_b64_tr_b16 v[126:127], v16 offset:20992
    ds_read_b64_tr_b16 v[128:129], v16 offset:28672
    s_waitcnt lgkmcnt(8)
    v_mfma_f32_32x32x16_bf16 v[208:223], v[148:151], v[140:143], v[208:223]
    ds_read_b64_tr_b16 v[130:131], v16 offset:29184
    ds_read_b64_tr_b16 v[132:133], v16 offset:36864
    ds_read_b64_tr_b16 v[134:135], v16 offset:37376
    buffer_load_dwordx4 v[76:79], v10, s[28:31], s43 offen offset:1024 sc1
    s_waitcnt lgkmcnt(9)
    v_mfma_f32_32x32x16_bf16 v[224:239], v[152:155], v[140:143], v[224:239]
    ds_read_b64_tr_b16 v[136:137], v17 offset:43008
    ds_read_b64_tr_b16 v[138:139], v17 offset:43264
    s_add_u32 s43, s47, 2
    s_and_b32 s43, s43, 3
    s_mul_i32 s43, s43, 6144
    s_add_u32 s43, s43, s57
    s_add_u32 s43, s43, 4096
    buffer_load_dwordx4 v[80:83], v10, s[28:31], s43 offen offset:0 sc1
    s_waitcnt lgkmcnt(9)
    v_mfma_f32_32x32x16_bf16 v[240:255], v[156:159], v[140:143], v[240:255]
    buffer_load_dwordx4 v[84:87], v10, s[28:31], s43 offen offset:1024 sc1
    s_waitcnt lgkmcnt(6)
    v_mfma_f32_32x32x16_bf16 v[192:207], v[124:127], v[120:123], v[192:207]
    ds_read_b128 v[140:143], v9
    ds_read_b64_tr_b16 v[144:145], v16 offset:22528
    ds_read_b64_tr_b16 v[146:147], v16 offset:23040
    ds_read_b64_tr_b16 v[148:149], v16 offset:30720
    s_waitcnt lgkmcnt(8)
    v_mfma_f32_32x32x16_bf16 v[208:223], v[128:131], v[120:123], v[208:223]
    ds_read_b64_tr_b16 v[150:151], v16 offset:31232
    ds_read_b64_tr_b16 v[152:153], v16 offset:38912
    ds_read_b64_tr_b16 v[154:155], v16 offset:39424
    buffer_load_dwordx4 v[88:91], v10, s[28:31], s43 offen offset:2048 sc1
    s_waitcnt lgkmcnt(9)
    v_mfma_f32_32x32x16_bf16 v[224:239], v[132:135], v[120:123], v[224:239]
    ds_read_b64_tr_b16 v[156:157], v17 offset:44032
    ds_read_b64_tr_b16 v[158:159], v17 offset:44288
    buffer_load_dwordx4 v[92:95], v10, s[28:31], s43 offen offset:3072 sc1
    s_waitcnt lgkmcnt(9)
    v_mfma_f32_32x32x16_bf16 v[240:255], v[136:139], v[120:123], v[240:255]
    s_waitcnt lgkmcnt(6)
    v_mfma_f32_32x32x16_bf16 v[192:207], v[144:147], v[140:143], v[192:207]
    s_waitcnt vmcnt(15)
    v_min3_u32 v104, v103, v107, v111
    v_cmp_ne_u32 s[16:17], 0, v104
    s_waitcnt vmcnt(14)
    v_cmp_ne_u32 s[18:19], 0, v115
    v_cmp_ne_u32 vcc, 0, v96
    s_or_b32 s16, s16, 0xf0000000
    s_and_b32 vcc_lo, vcc_lo, s16
    s_and_b32 vcc_lo, vcc_lo, s18
    s_cmp_eq_u64 vcc, -1
    s_cbranch_scc1 SPD_19
    s_mov_b32 s54, 50000
SPL_18:
    s_sleep 2
    v_and_b32 v160, 31, v1
    v_lshlrev_b32 v161, 4, v160
    s_lshl_b32 s48, s5, 2
    s_and_b32 s49, s3, 3
    s_add_u32 s48, s48, s49
    s_lshl_b32 s48, s48, 9
    s_add_u32 s48, s48, 0x1028000
    buffer_load_dwordx4 v[96:99], v161, s[20:23], s48 offen sc1
    v_lshlrev_b32 v161, 3, v1
    v_mov_b32 v160, 0x40000000
    v_cmp_gt_u32 vcc, 28, v1
    s_nop 1
    v_cndmask_b32 v161, v160, v161, vcc
    s_lshr_b32 s49, s3, 2
    s_lshl_b32 s48, s45, 1
    s_add_u32 s48, s48, s49
    s_mul_i32 s48, s48, 224
    s_add_u32 s48, s48, 0x1037000
    s_add_u32 s50, s48, 3584
    buffer_load_dwordx2 v[102:103], v161, s[20:23], s50 offen sc1
    buffer_load_dwordx2 v[106:107], v161, s[20:23], s50 offen offset:3584 sc1
    buffer_load_dwordx2 v[110:111], v161, s[20:23], s48 offen sc1
    v_and_b32 v161, 15, v1
    v_lshlrev_b32 v161, 3, v161
    v_lshrrev_b32 v160, 4, v1
    v_mul_u32_u24 v14, 14336, v160
    v_add_u32 v161, v161, v14
    v_lshrrev_b32 v160, 1, v160
    v_lshl_add_u32 v161, v160, 30, v161
    s_mul_i32 s48, s4, 28
    s_lshl_b32 s50, s6, 1
    s_add_u32 s48, s48, s50
    s_add_u32 s48, s48, s49
    s_add_u32 s48, s48, 20
    s_lshl_b32 s44, s48, 10
    s_add_u32 s44, s44, s53
    s_lshl_b32 s48, s48, 7
    s_add_u32 s48, s48, 0x1030000
    buffer_load_dwordx2 v[114:115], v161, s[20:23], s48 offen sc1
    s_waitcnt vmcnt(0)
    s_sub_u32 s54, s54, 1
    s_cbranch_scc1 SPD_19
    v_min3_u32 v104, v103, v107, v111
    v_cmp_ne_u32 s[16:17], 0, v104
    v_cmp_ne_u32 s[18:19], 0, v115
    v_cmp_ne_u32 vcc, 0, v96
    s_or_b32 s16, s16, 0xf0000000
    s_and_b32 vcc_lo, vcc_lo, s16
    s_and_b32 vcc_lo, vcc_lo, s18
    s_cmp_eq_u64 vcc, -1
    s_cbranch_scc0 SPL_18
SPD_19:
    v_mov_b32 v100, 0
    v_mov_b32 v101, 0
    v_mov_b32 v104, 0
    v_mov_b32 v105, 0
    v_mov_b32 v108, 0
    s_waitcnt lgkmcnt(4)
    v_mfma_f32_32x32x16_bf16 v[208:223], v[148:151], v[140:143], v[208:223]
    v_mov_b32 v109, 0
    v_mov_b32 v112, 0
    v_mov_b32 v113, 0
    v_mov_b32 v116, 0
    v_mov_b32 v117, 0
    s_waitcnt lgkmcnt(2)
    v_mfma_f32_32x32x16_bf16 v[224:239], v[152:155], v[140:143], v[224:239]
    s_waitcnt lgkmcnt(0)
    v_mfma_f32_32x32x16_bf16 v[240:255], v[156:159], v[140:143], v[240:255]
    v_mfma_f32_32x32x16_bf16 v[192:207], v[102:105], v[98:101], v[192:207]
    v_mfma_f32_32x32x16_bf16 v[208:223], v[106:109], v[98:101], v[208:223]
    v_mfma_f32_32x32x16_bf16 v[224:239], v[110:113], v[98:101], v[224:239]
    v_mfma_f32_32x32x16_bf16 v[240:255], v[114:117], v[98:101], v[240:255]
    v_mul_f32 v158, 0x3fb8aa3b, v96
    v_mul_f32 v159, 0x3fb8aa3b, v96
    s_mov_b32 s54, 0x42700000
    s_nop 5
    v_pk_mul_f32 v[192:193], v[192:193], v[158:159]
    v_pk_mul_f32 v[194:195], v[194:195], v[158:159]
    v_pk_mul_f32 v[196:197], v[196:197], v[158:159]
    v_pk_mul_f32 v[198:199], v[198:199], v[158:159]
    v_pk_mul_f32 v[200:201], v[200:201], v[158:159]
    v_pk_mul_f32 v[202:203], v[202:203], v[158:159]
    v_pk_mul_f32 v[204:205], v[204:205], v[158:159]
    v_pk_mul_f32 v[206:207], v[206:207], v[158:159]
    v_cvt_pk_bf16_f32 v192, v192, v193
    v_cvt_pk_bf16_f32 v193, v194, v195
    v_cvt_pk_bf16_f32 v194, v196, v197
    v_cvt_pk_bf16_f32 v195, v198, v199
    v_cvt_pk_bf16_f32 v196, v200, v201
    v_cvt_pk_bf16_f32 v197, v202, v203
    v_cvt_pk_bf16_f32 v198, v204, v205
    v_cvt_pk_bf16_f32 v199, v206, v207
    v_mfma_f32_32x32x16_bf16 v[120:135], v[20:23], v[192:195], 0
    s_nop 0
    v_mfma_f32_32x32x16_bf16 v[120:135], v[24:27], v[196:199], v[120:135]
    s_mov_b32 s48, 0x5d800000
    s_nop 7
    s_nop 2
    v_exp_f32 v136, -v120
    v_exp_f32 v120, v120
    v_exp_f32 v137, -v121
    v_exp_f32 v121, v121
    v_exp_f32 v138, -v122
    v_exp_f32 v122, v122
    v_exp_f32 v139, -v123
    v_exp_f32 v123, v123
    v_exp_f32 v140, -v124
    v_exp_f32 v124, v124
    v_exp_f32 v141, -v125
    v_exp_f32 v125, v125
    v_exp_f32 v142, -v126
    v_exp_f32 v126, v126
    v_exp_f32 v143, -v127
    v_exp_f32 v127, v127
    v_exp_f32 v144, -v128
    v_exp_f32 v128, v128
    v_exp_f32 v145, -v129
    v_exp_f32 v129, v129
    v_exp_f32 v146, -v130
    v_exp_f32 v130, v130
    v_exp_f32 v147, -v131
    v_exp_f32 v131, v131
    v_exp_f32 v148, -v132
    v_exp_f32 v132, v132
    v_exp_f32 v149, -v133
    v_exp_f32 v133, v133
    v_exp_f32 v150, -v134
    v_exp_f32 v134, v134
    v_exp_f32 v151, -v135
    v_exp_f32 v135, v135
XK_R:
    s_nop 0
    v_cvt_pk_bf16_f32 v120, v120, v121
    v_cvt_pk_bf16_f32 v121, v122, v123
    v_cvt_pk_bf16_f32 v122, v124, v125
    v_cvt_pk_bf16_f32 v123, v126, v127
    v_cvt_pk_bf16_f32 v124, v128, v129
    v_cvt_pk_bf16_f32 v125, v130, v131
    v_cvt_pk_bf16_f32 v126, v132, v133
    v_cvt_pk_bf16_f32 v127, v134, v135
    v_mfma_f32_32x32x16_bf16 v[160:175], v[28:31], v[120:123], 0
    s_nop 0
    v_mfma_f32_32x32x16_bf16 v[160:175], v[30:33], v[124:127], v[160:175]
    v_cvt_pk_bf16_f32 v136, v136, v137
    v_cvt_pk_bf16_f32 v137, v138, v139
    v_cvt_pk_bf16_f32 v138, v140, v141
    v_cvt_pk_bf16_f32 v139, v142, v143
    v_cvt_pk_bf16_f32 v140, v144, v145
    v_cvt_pk_bf16_f32 v141, v146, v147
    v_cvt_pk_bf16_f32 v142, v148, v149
    v_cvt_pk_bf16_f32 v143, v150, v151
    v_mfma_f32_32x32x16_bf16 v[176:191], v[28:31], v[136:139], 0
    s_nop 0
    v_mfma_f32_32x32x16_bf16 v[176:191], v[30:33], v[140:143], v[176:191]
    ds_write_b64 v34, v[120:121]
    ds_write_b64 v34, v[136:137] offset:64
    ds_write_b64 v35, v[122:123]
    ds_write_b64 v35, v[138:139] offset:64
    ds_write_b64 v36, v[124:125]
    ds_write_b64 v36, v[140:141] offset:64
    ds_write_b64 v37, v[126:127]
    ds_write_b64 v37, v[142:143] offset:64
    v_rcp_f32 v152, v160
    v_cmp_lt_f32 vcc, s48, v160
    s_cbranch_vccnz XK_S
    v_mul_f32 v154, v152, v96
    v_mul_f32 v155, v152, v96
    v_pk_mul_f32 v[160:161], v[208:209], v[154:155]
    v_pk_mul_f32 v[162:163], v[210:211], v[154:155]
    v_pk_mul_f32 v[164:165], v[212:213], v[154:155]
    v_pk_mul_f32 v[166:167], v[214:215], v[154:155]
    v_pk_mul_f32 v[168:169], v[216:217], v[154:155]
    v_pk_mul_f32 v[170:171], v[218:219], v[154:155]
    v_pk_mul_f32 v[172:173], v[220:221], v[154:155]
    v_pk_mul_f32 v[174:175], v[222:223], v[154:155]
    v_cvt_pk_bf16_f32 v160, v160, v161
    v_cvt_pk_bf16_f32 v161, v162, v163
    v_cvt_pk_bf16_f32 v162, v164, v165
    v_cvt_pk_bf16_f32 v163, v166, v167
    v_cvt_pk_bf16_f32 v164, v168, v169
    v_cvt_pk_bf16_f32 v165, v170, v171
    v_cvt_pk_bf16_f32 v166, v172, v173
    v_cvt_pk_bf16_f32 v167, v174, v175
    s_mov_b32 exec_lo, 0
    v_cvt_pk_bf16_f32 v166, v152, 0
    v_mov_b32 v167, 0
    s_mov_b32 exec_lo, -1
    ds_write_b64 v34, v[160:161] offset:128
    ds_write_b64 v35, v[162:163] offset:128
    ds_write_b64 v36, v[164:165] offset:128
    ds_write_b64 v37, v[166:167] offset:128
    v_rcp_f32 v153, v176
    v_cmp_lt_f32 vcc, s48, v176
    s_cbranch_vccnz XK_S
    v_mul_f32 v156, v153, v96
    v_mul_f32 v157, v153, v96
    v_pk_mul_f32 v[176:177], v[208:209], v[156:157]
    v_pk_mul_f32 v[178:179], v[210:211], v[156:157]
    v_pk_mul_f32 v[180:181], v[212:213], v[156:157]
    v_pk_mul_f32 v[182:183], v[214:215], v[156:157]
    v_pk_mul_f32 v[184:185], v[216:217], v[156:157]
    v_pk_mul_f32 v[186:187], v[218:219], v[156:157]
    v_pk_mul_f32 v[188:189], v[220:221], v[156:157]
    v_pk_mul_f32 v[190:191], v[222:223], v[156:157]
    v_cvt_pk_bf16_f32 v176, v176, v177
    v_cvt_pk_bf16_f32 v177, v178, v179
    v_cvt_pk_bf16_f32 v178, v180, v181
    v_cvt_pk_bf16_f32 v179, v182, v183
    v_cvt_pk_bf16_f32 v180, v184, v185
    v_cvt_pk_bf16_f32 v181, v186, v187
    v_cvt_pk_bf16_f32 v182, v188, v189
    v_cvt_pk_bf16_f32 v183, v190, v191
    s_mov_b32 exec_lo, 0
    v_cvt_pk_bf16_f32 v182, v153, 0
    v_mov_b32 v183, 0
    s_mov_b32 exec_lo, -1
    ds_write_b64 v34, v[176:177] offset:192
    ds_write_b64 v35, v[178:179] offset:192
    ds_write_b64 v36, v[180:181] offset:192
    ds_write_b64 v37, v[182:183] offset:192
    s_waitcnt lgkmcnt(0)
    s_barrier
    s_and_b32 s49, s3, 3
    s_lshl2_add_u32 s52, s45, s49
    s_cmp_ge_u32 s3, 4
    s_cbranch_scc1 SK_20
    s_setprio 2
    ds_read_b64_tr_b16 v[120:121], v38 offset:0
    ds_read_b64_tr_b16 v[122:123], v39 offset:0
    ds_read_b64_tr_b16 v[124:125], v38 offset:128
    ds_read_b64_tr_b16 v[126:127], v39 offset:128
    ds_read_b64_tr_b16 v[128:129], v118 offset:5120
    ds_read_b64_tr_b16 v[130:131], v119 offset:5120
    ds_read_b64_tr_b16 v[132:133], v118 offset:5248
    ds_read_b64_tr_b16 v[134:135], v119 offset:5248
    ds_read_b64_tr_b16 v[136:137], v38 offset:10240
    ds_read_b64_tr_b16 v[138:139], v39 offset:10240
    ds_read_b64_tr_b16 v[140:141], v38 offset:10368
    ds_read_b64_tr_b16 v[142:143], v39 offset:10368
    s_waitcnt lgkmcnt(8)
    v_mfma_f32_32x32x16_bf16 v[192:207], v[120:123], v[124:127], 0
    ds_read_b64_tr_b16 v[144:145], v118 offset:15360
    ds_read_b64_tr_b16 v[146:147], v119 offset:15360
    ds_read_b64_tr_b16 v[148:149], v118 offset:15488
    ds_read_b64_tr_b16 v[150:151], v119 offset:15488
    s_waitcnt lgkmcnt(8)
    v_mfma_f32_32x32x16_bf16 v[208:223], v[128:131], v[132:135], 0
    ds_read_b64_tr_b16 v[152:153], v38 offset:20480
    ds_read_b64_tr_b16 v[154:155], v39 offset:20480
    ds_read_b64_tr_b16 v[156:157], v38 offset:20608
    ds_read_b64_tr_b16 v[158:159], v39 offset:20608
    s_waitcnt lgkmcnt(8)
    v_mfma_f32_32x32x16_bf16 v[192:207], v[136:139], v[140:143], v[192:207]
    ds_read_b64_tr_b16 v[160:161], v118 offset:25600
    ds_read_b64_tr_b16 v[162:163], v119 offset:25600
    ds_read_b64_tr_b16 v[164:165], v118 offset:25728
    ds_read_b64_tr_b16 v[166:167], v119 offset:25728
    s_waitcnt lgkmcnt(8)
    v_mfma_f32_32x32x16_bf16 v[208:223], v[144:147], v[148:151], v[208:223]
    ds_read_b64_tr_b16 v[168:169], v38 offset:30720
    ds_read_b64_tr_b16 v[170:171], v39 offset:30720
    ds_read_b64_tr_b16 v[172:173], v38 offset:30848
    ds_read_b64_tr_b16 v[174:175], v39 offset:30848
    s_waitcnt lgkmcnt(8)
    v_mfma_f32_32x32x16_bf16 v[192:207], v[152:155], v[156:159], v[192:207]
    ds_read_b64_tr_b16 v[176:177], v118 offset:35840
    ds_read_b64_tr_b16 v[178:179], v119 offset:35840
    ds_read_b64_tr_b16 v[180:181], v118 offset:35968
    ds_read_b64_tr_b16 v[182:183], v119 offset:35968
    s_waitcnt lgkmcnt(8)
    v_mfma_f32_32x32x16_bf16 v[208:223], v[160:163], v[164:167], v[208:223]
    s_waitcnt lgkmcnt(4)
    v_mfma_f32_32x32x16_bf16 v[192:207], v[168:171], v[172:175], v[192:207]
    s_waitcnt lgkmcnt(0)
    v_mfma_f32_32x32x16_bf16 v[208:223], v[176:179], v[180:183], v[208:223]
    s_lshl_b32 s48, s52, 12
    s_add_u32 s48, s48, 0x1000000
    v_lshlrev_b32 v2, 2, v1
    s_mov_b32 exec_lo, 0x1fffffff
    s_mov_b32 exec_hi, 0x1fffffff
    s_nop 6
    v_pk_add_f32 v[192:193], v[192:193], v[208:209]
    buffer_atomic_add_f32 v192, v2, s[20:23], s48 offen offset:0 sc1
    buffer_atomic_add_f32 v193, v2, s[20:23], s48 offen offset:256 sc1
    v_pk_add_f32 v[194:195], v[194:195], v[210:211]
    buffer_atomic_add_f32 v194, v2, s[20:23], s48 offen offset:512 sc1
    buffer_atomic_add_f32 v195, v2, s[20:23], s48 offen offset:768 sc1
    v_pk_add_f32 v[196:197], v[196:197], v[212:213]
    buffer_atomic_add_f32 v196, v2, s[20:23], s48 offen offset:1024 sc1
    buffer_atomic_add_f32 v197, v2, s[20:23], s48 offen offset:1280 sc1
    v_pk_add_f32 v[198:199], v[198:199], v[214:215]
    buffer_atomic_add_f32 v198, v2, s[20:23], s48 offen offset:1536 sc1
    buffer_atomic_add_f32 v199, v2, s[20:23], s48 offen offset:1792 sc1
    v_pk_add_f32 v[200:201], v[200:201], v[216:217]
    buffer_atomic_add_f32 v200, v2, s[20:23], s48 offen offset:2048 sc1
    buffer_atomic_add_f32 v201, v2, s[20:23], s48 offen offset:2304 sc1
    v_pk_add_f32 v[202:203], v[202:203], v[218:219]
    buffer_atomic_add_f32 v202, v2, s[20:23], s48 offen offset:2560 sc1
    buffer_atomic_add_f32 v203, v2, s[20:23], s48 offen offset:2816 sc1
    v_pk_add_f32 v[204:205], v[204:205], v[220:221]
    s_mov_b32 exec_hi, 0
    buffer_atomic_add_f32 v204, v2, s[20:23], s48 offen offset:3072 sc1
    buffer_atomic_add_f32 v205, v2, s[20:23], s48 offen offset:3328 sc1
    v_pk_add_f32 v[206:207], v[206:207], v[222:223]
    buffer_atomic_add_f32 v206, v2, s[20:23], s48 offen offset:3584 sc1
    buffer_atomic_add_f32 v207, v2, s[20:23], s48 offen offset:3840 sc1
    s_mov_b64 exec, -1
    s_setprio 0
SK_20:
    s_cmp_lg_u32 s30, 0
    s_cbranch_scc1 SK_21
    buffer_load_dword v18, v19, s[20:23], 0 offen sc1
    s_waitcnt vmcnt(0)
    v_cmp_ne_u32 vcc, 0, v18
    s_cmp_eq_u64 vcc, -1
    s_cbranch_scc1 SPD_23
    s_mov_b32 s54, 50000
SPL_22:
    s_sleep 2
    buffer_load_dword v18, v19, s[20:23], 0 offen sc1
    s_waitcnt vmcnt(0)
    s_sub_u32 s54, s54, 1
    s_cbranch_scc1 SPD_23
    v_cmp_ne_u32 vcc, 0, v18
    s_cmp_eq_u64 vcc, -1
    s_cbranch_scc0 SPL_22
SPD_23:
    s_mov_b32 s54, 0x42700000
    s_cmp_ge_u32 s2, 224
    s_cselect_b32 s30, 0, 0x10000000
    s_add_u32 s43, s47, 0
    s_and_b32 s43, s43, 3
    s_mul_i32 s43, s43, 6144
    s_add_u32 s43, s43, s57
    s_add_u32 s43, s43, 4096
    buffer_load_dwordx4 v[40:43], v10, s[28:31], s43 offen offset:2048 sc1
    buffer_load_dwordx4 v[44:47], v10, s[28:31], s43 offen offset:3072 sc1
    s_add_u32 s43, s43, 4096
    buffer_load_dwordx4 v[48:51], v10, s[28:31], s43 offen offset:0 sc1
    buffer_load_dwordx4 v[52:55], v10, s[28:31], s43 offen offset:1024 sc1
    s_add_u32 s43, s47, 1
    s_and_b32 s43, s43, 3
    s_mul_i32 s43, s43, 6144
    s_add_u32 s43, s43, s57
    s_add_u32 s43, s43, 4096
    buffer_load_dwordx4 v[56:59], v10, s[28:31], s43 offen offset:0 sc1
    buffer_load_dwordx4 v[60:63], v10, s[28:31], s43 offen offset:1024 sc1
    buffer_load_dwordx4 v[64:67], v10, s[28:31], s43 offen offset:2048 sc1
    buffer_load_dwordx4 v[68:71], v10, s[28:31], s43 offen offset:3072 sc1
    s_add_u32 s43, s43, 4096
    buffer_load_dwordx4 v[72:75], v10, s[28:31], s43 offen offset:0 sc1
    buffer_load_dwordx4 v[76:79], v10, s[28:31], s43 offen offset:1024 sc1
    s_add_u32 s43, s47, 2
    s_and_b32 s43, s43, 3
    s_mul_i32 s43, s43, 6144
    s_add_u32 s43, s43, s57
    s_add_u32 s43, s43, 4096
    buffer_load_dwordx4 v[80:83], v10, s[28:31], s43 offen offset:0 sc1
    buffer_load_dwordx4 v[84:87], v10, s[28:31], s43 offen offset:1024 sc1
    buffer_load_dwordx4 v[88:91], v10, s[28:31], s43 offen offset:2048 sc1
    buffer_load_dwordx4 v[92:95], v10, s[28:31], s43 offen offset:3072 sc1
SK_21:
    v_mul_f32 v2, 0x3fb8aa3b, v96
    v_mul_f32 v3, 0x3fb8aa3b, v96
    v_mul_f32 v4, 0x2b800000, v97
    v_mul_f32 v5, 0x2b800000, v97
    s_add_u32 s43, s47, 3
    s_and_b32 s43, s43, 3
    s_mul_i32 s43, s43, 6144
    s_add_u32 s43, s43, s57
    s_add_u32 s43, s43, 8192
    s_waitcnt lgkmcnt(15)
    buffer_load_dwordx4 v[120:123], v10, s[28:31], s43 offen offset:0 sc1
    buffer_load_dwordx4 v[124:127], v10, s[28:31], s43 offen offset:1024 sc1
    s_add_u32 s43, s57, 28672
    buffer_load_dwordx4 v[128:131], v10, s[28:31], s43 offen offset:0 sc1
    buffer_load_dwordx4 v[132:135], v10, s[28:31], s43 offen offset:1024 sc1
    buffer_load_dwordx4 v[136:139], v10, s[28:31], s43 offen offset:2048 sc1
    buffer_load_dwordx4 v[140:143], v10, s[28:31], s43 offen offset:3072 sc1
    s_add_u32 s43, s57, 32768
    buffer_load_dwordx4 v[144:147], v10, s[28:31], s43 offen offset:0 sc1
    buffer_load_dwordx4 v[148:151], v10, s[28:31], s43 offen offset:1024 sc1
    s_waitcnt lgkmcnt(14)
    buffer_load_dwordx4 v[152:155], v10, s[28:31], s43 offen offset:2048 sc1
    s_waitcnt lgkmcnt(12)
    buffer_load_dwordx4 v[156:159], v10, s[28:31], s43 offen offset:3072 sc1
    s_cmp_lt_u32 s3, 4
    s_cbranch_scc1 SK_24
    s_add_u32 s43, s47, 2
    s_and_b32 s43, s43, 3
    s_mul_i32 s43, s43, 6144
    s_add_u32 s43, s43, s57
    s_add_u32 s43, s43, 8192
    buffer_load_dwordx4 v[96:99], v10, s[28:31], s43 offen offset:0 sc1
    buffer_load_dwordx4 v[100:103], v10, s[28:31], s43 offen offset:1024 sc1
    s_add_u32 s43, s47, 3
    s_and_b32 s43, s43, 3
    s_mul_i32 s43, s43, 6144
    s_add_u32 s43, s43, s57
    s_add_u32 s43, s43, 4096
    buffer_load_dwordx4 v[104:107], v10, s[28:31], s43 offen offset:0 sc1
    buffer_load_dwordx4 v[108:111], v10, s[28:31], s43 offen offset:1024 sc1
    buffer_load_dwordx4 v[112:115], v10, s[28:31], s43 offen offset:2048 sc1
    buffer_load_dwordx4 v[116:119], v10, s[28:31], s43 offen offset:3072 sc1
SK_24:
    v_pk_mul_f32 v[224:225], v[224:225], v[2:3]
    v_pk_mul_f32 v[226:227], v[226:227], v[2:3]
    v_pk_mul_f32 v[228:229], v[228:229], v[2:3]
    v_pk_mul_f32 v[230:231], v[230:231], v[2:3]
    v_pk_mul_f32 v[232:233], v[232:233], v[2:3]
    v_pk_mul_f32 v[234:235], v[234:235], v[2:3]
    v_pk_mul_f32 v[236:237], v[236:237], v[2:3]
    v_pk_mul_f32 v[238:239], v[238:239], v[2:3]
    v_cvt_pk_bf16_f32 v224, v224, v225
    v_cvt_pk_bf16_f32 v225, v226, v227
    v_cvt_pk_bf16_f32 v226, v228, v229
    v_cvt_pk_bf16_f32 v227, v230, v231
    v_cvt_pk_bf16_f32 v228, v232, v233
    v_cvt_pk_bf16_f32 v229, v234, v235
    v_cvt_pk_bf16_f32 v230, v236, v237
    v_cvt_pk_bf16_f32 v231, v238, v239
    v_pk_mul_f32 v[240:241], v[240:241], v[4:5] clamp
    v_pk_mul_f32 v[242:243], v[242:243], v[4:5] clamp
    v_pk_mul_f32 v[244:245], v[244:245], v[4:5] clamp
    v_pk_mul_f32 v[246:247], v[246:247], v[4:5] clamp
    v_pk_mul_f32 v[240:241], v[240:241], v[248:249]
    v_pk_mul_f32 v[242:243], v[242:243], v[250:251]
    v_pk_mul_f32 v[244:245], v[244:245], v[252:253]
    v_pk_mul_f32 v[246:247], v[246:247], v[254:255]
    s_waitcnt lgkmcnt(3)
    v_cvt_pk_bf16_f32 v176, v240, v241
    v_cvt_pk_bf16_f32 v177, v242, v243
    s_waitcnt lgkmcnt(2)
    v_cvt_pk_bf16_f32 v178, v244, v245
    v_cvt_pk_bf16_f32 v179, v246, v247
    buffer_store_dwordx4 v[176:179], v10, s[20:23], s44 offen offset:0 sc1
    v_mfma_f32_32x32x16_bf16 v[240:255], v[20:23], v[224:227], 0
    v_mfma_f32_32x32x16_bf16 v[240:255], v[24:27], v[228:231], v[240:255]
    s_cmp_lt_u32 s3, 4
    s_cbranch_scc1 SK_25
    s_add_u32 s43, s57, 0
    s_waitcnt vmcnt(25)
    buffer_load_dwordx4 v[16:19], v10, s[28:31], s43 offen offset:0 sc1
    buffer_load_dwordx4 v[20:23], v10, s[28:31], s43 offen offset:1024 sc1
    buffer_load_dwordx4 v[24:27], v10, s[28:31], s43 offen offset:2048 sc1
    buffer_load_dwordx4 v[28:31], v10, s[28:31], s43 offen offset:3072 sc1
    s_add_u32 s43, s47, 0
    s_and_b32 s43, s43, 3
    s_mul_i32 s43, s43, 6144
    s_add_u32 s43, s43, s57
    s_add_u32 s43, s43, 4096
    buffer_load_dwordx4 v[32:35], v10, s[28:31], s43 offen offset:0 sc1
    buffer_load_dwordx4 v[36:39], v10, s[28:31], s43 offen offset:1024 sc1
SK_25:
    s_nop 7
    s_nop 1
    v_max3_f32 v160, |v240|, |v241|, |v242|
    v_max3_f32 v161, |v243|, |v244|, |v245|
    v_max3_f32 v160, |v246|, |v247|, v160
    v_max3_f32 v161, |v248|, |v249|, v161
    v_max3_f32 v160, |v250|, |v251|, v160
    v_max3_f32 v161, |v252|, |v253|, v161
    v_max3_f32 v160, |v254|, |v255|, v160
    v_max_f32 v160, v160, v161
    v_cmp_nle_f32 vcc, v160, s54
    s_cbranch_vccnz XQ_S
    v_exp_f32 v160, -v240
    v_exp_f32 v240, v240
    v_exp_f32 v161, -v241
    v_exp_f32 v241, v241
    v_exp_f32 v162, -v242
    v_exp_f32 v242, v242
    v_exp_f32 v163, -v243
    v_exp_f32 v243, v243
    v_exp_f32 v164, -v244
    v_exp_f32 v244, v244
    v_exp_f32 v165, -v245
    v_exp_f32 v245, v245
    v_exp_f32 v166, -v246
    v_exp_f32 v246, v246
    v_exp_f32 v167, -v247
    v_exp_f32 v247, v247
    v_exp_f32 v168, -v248
    v_exp_f32 v248, v248
    v_exp_f32 v169, -v249
    v_exp_f32 v249, v249
    v_exp_f32 v170, -v250
    v_exp_f32 v250, v250
    v_exp_f32 v171, -v251
    v_exp_f32 v251, v251
    v_exp_f32 v172, -v252
    v_exp_f32 v252, v252
    v_exp_f32 v173, -v253
    v_exp_f32 v253, v253
    v_exp_f32 v174, -v254
    v_exp_f32 v254, v254
    v_exp_f32 v175, -v255
    v_exp_f32 v255, v255
XQ_R:
    s_nop 0
    s_lshl_b32 s48, s52, 7
    s_add_u32 s48, s48, 0x103c000
    s_cmp_ge_u32 s3, 4
    s_cbranch_scc1 SK_26
    s_lshl2_add_u32 s49, s5, s48
    v_mov_b32 v4, s49
    v_mov_b32 v9, 1
    s_waitcnt vmcnt(11)
    s_mov_b64 exec, 1
    buffer_store_dword v9, v4, s[20:23], 0 offen sc1
    s_mov_b64 exec, -1
    s_add_u32 s43, s57, 0
    s_waitcnt vmcnt(6)
    buffer_load_dwordx4 v[16:19], v10, s[28:31], s43 offen offset:0 sc1
    s_waitcnt vmcnt(6)
    buffer_load_dwordx4 v[20:23], v10, s[28:31], s43 offen offset:1024 sc1
    s_waitcnt vmcnt(6)
    buffer_load_dwordx4 v[24:27], v10, s[28:31], s43 offen offset:2048 sc1
    s_waitcnt vmcnt(6)
    buffer_load_dwordx4 v[28:31], v10, s[28:31], s43 offen offset:3072 sc1
    s_add_u32 s43, s47, 0
    s_and_b32 s43, s43, 3
    s_mul_i32 s43, s43, 6144
    s_add_u32 s43, s43, s57
    s_add_u32 s43, s43, 4096
    s_waitcnt vmcnt(6)
    buffer_load_dwordx4 v[32:35], v10, s[28:31], s43 offen offset:0 sc1
    s_waitcnt vmcnt(6)
    buffer_load_dwordx4 v[36:39], v10, s[28:31], s43 offen offset:1024 sc1
    s_add_u32 s43, s47, 2
    s_and_b32 s43, s43, 3
    s_mul_i32 s43, s43, 6144
    s_add_u32 s43, s43, s57
    s_add_u32 s43, s43, 8192
    buffer_load_dwordx4 v[96:99], v10, s[28:31], s43 offen offset:0 sc1
    buffer_load_dwordx4 v[100:103], v10, s[28:31], s43 offen offset:1024 sc1
    s_add_u32 s43, s47, 3
    s_and_b32 s43, s43, 3
    s_mul_i32 s43, s43, 6144
    s_add_u32 s43, s43, s57
    s_add_u32 s43, s43, 4096
    buffer_load_dwordx4 v[104:107], v10, s[28:31], s43 offen offset:0 sc1
    buffer_load_dwordx4 v[108:111], v10, s[28:31], s43 offen offset:1024 sc1
    buffer_load_dwordx4 v[112:115], v10, s[28:31], s43 offen offset:2048 sc1
    buffer_load_dwordx4 v[116:119], v10, s[28:31], s43 offen offset:3072 sc1
SK_26:
    v_cvt_pk_bf16_f32 v224, v240, v241
    v_cvt_pk_bf16_f32 v225, v242, v243
    v_cvt_pk_bf16_f32 v226, v244, v245
    v_cvt_pk_bf16_f32 v227, v246, v247
    v_cvt_pk_bf16_f32 v228, v248, v249
    v_cvt_pk_bf16_f32 v229, v250, v251
    v_cvt_pk_bf16_f32 v230, v252, v253
    v_cvt_pk_bf16_f32 v231, v254, v255
    v_cvt_pk_bf16_f32 v232, v160, v161
    v_cvt_pk_bf16_f32 v233, v162, v163
    v_cvt_pk_bf16_f32 v234, v164, v165
    v_cvt_pk_bf16_f32 v235, v166, v167
    v_cvt_pk_bf16_f32 v236, v168, v169
    v_cvt_pk_bf16_f32 v237, v170, v171
    v_cvt_pk_bf16_f32 v238, v172, v173
    v_cvt_pk_bf16_f32 v239, v174, v175
    v_and_b32 v2, 15, v1
    v_lshl_add_u32 v2, v2, 2, s48
    s_lshr_b32 s49, s58, 3
    s_and_b32 s48, s3, 1
    s_lshr_b32 s50, s49, 1
    s_and_b32 s49, s49, 1
    s_lshl_b32 s50, s50, 4
    s_lshr_b32 s51, s3, 1
    s_lshl_b32 s51, s51, 2
    s_add_u32 s50, s50, s51
    s_add_u32 s50, s50, s48
    s_lshl_b32 s50, s50, 7
    s_add_u32 s50, s50, 0x1020000
    s_lshl_b32 s49, s49, 2
    s_add_u32 s50, s50, s49
    v_and_b32 v3, 3, v1
    v_lshl_add_u32 v8, v3, 3, s50
    s_add_u32 s50, s50, s49
    s_add_u32 s50, s50, 256
    v_and_b32 v3, 1, v1
    v_bfe_u32 v4, v1, 1, 1
    v_lshlrev_b32 v3, 2, v3
    v_lshl_add_u32 v3, v4, 4, v3
    v_add_u32 v3, s50, v3
    v_cmp_gt_u32 vcc, 4, v1
    s_nop 1
    v_cndmask_b32 v8, v3, v8, vcc
    buffer_load_dword v9, v8, s[20:23], 0 offen sc1
    s_and_b32 s50, s58, 7
    s_lshr_b32 s49, s58, 3
    s_mul_i32 s58, s49, 294912
    s_and_b32 s48, s3, 1
    s_mul_i32 s51, s48, 147456
    v_add_u32 v6, s51, v10
    s_xor_b32 s51, s51, 147456
    v_add_u32 v7, s51, v10
    s_lshl_b32 s51, s49, 1
    s_add_u32 s51, s51, s48
    s_lshl_b32 s51, s51, 5
    v_and_b32 v3, 31, v1
    v_add_u32 v3, s51, v3
    v_mul_u32_u24 v3, 896, v3
    v_lshrrev_b32 v4, 5, v1
    v_lshl_add_u32 v3, v4, 4, v3
    s_lshl_b32 s50, s50, 7
    s_bfe_u32 s51, s3, 0x10001
    s_lshl_b32 s51, s51, 6
    s_add_u32 s50, s50, s51
    s_lshr_b32 s51, s3, 2
    s_lshl_b32 s51, s51, 5
    s_add_u32 s50, s50, s51
    v_add_u32 v5, s50, v3
    buffer_load_dwordx4 v[12:15], v5, s[8:11], 0 offen
    s_cmp_lt_u32 s3, 4
    s_cbranch_scc1 SK_27
    buffer_load_dword v0, v2, s[20:23], 0 offen sc1
    s_lshl_b32 s48, s7, 2
    s_add_u32 m0, s48, 16384
    s_lshl_b32 s48, s52, 12
    s_add_u32 s48, s48, 0x1000000
    s_waitcnt vmcnt(0)
    v_cmp_ne_u32 vcc, 0, v0
    s_cmp_eq_u64 vcc, -1
    s_cbranch_scc1 SPD_29
    s_mov_b32 s54, 50000
SPL_28:
    s_sleep 1
    buffer_load_dword v0, v2, s[20:23], 0 offen sc1
    s_waitcnt vmcnt(0)
    s_sub_u32 s54, s54, 1
    s_cbranch_scc1 SPD_29
    v_cmp_ne_u32 vcc, 0, v0
    s_cmp_eq_u64 vcc, -1
    s_cbranch_scc0 SPL_28
SPD_29:
    buffer_load_dwordx4 v10, s[20:23], s48 offen offset:0 sc1 lds
    buffer_load_dwordx4 v10, s[20:23], s48 offen offset:1024 sc1 lds
    buffer_load_dwordx4 v10, s[20:23], s48 offen offset:2048 sc1 lds
    buffer_load_dwordx4 v10, s[20:23], s48 offen offset:3072 sc1 lds
SK_27:
    s_lshr_b32 s48, s3, 2
    s_lshl_b32 s49, s48, 13
    s_add_u32 s49, s49, 32768
    v_lshl_add_u32 v2, v1, 2, s49
    s_lshl_b32 s49, s45, 1
    s_add_u32 s48, s48, s49
    s_lshl_b32 s48, s48, 11
    s_add_u32 s48, s48, s53
    s_add_u32 s44, s48, 114688
    v_mov_b32 v240, 0x3f803f80
    v_mov_b32 v241, 0x3f803f80
    v_mov_b32 v242, 0x3f803f80
    v_mov_b32 v243, 0x3f803f80
    v_mov_b32 v244, 0x3f803f80
    v_mov_b32 v245, 0x3f803f80
    v_mov_b32 v246, 0x3f803f80
    v_mov_b32 v247, 0x3f803f80
    v_mov_b32 v248, 0x3f803f80
    v_mov_b32 v249, 0x3f803f80
    v_mov_b32 v250, 0x3f803f80
    v_mov_b32 v251, 0x3f803f80
    v_mov_b32 v252, 0x3f803f80
    v_mov_b32 v253, 0x3f803f80
    v_mov_b32 v254, 0x3f803f80
    v_mov_b32 v255, 0x3f803f80
    s_cmp_lt_u32 s3, 4
    s_cbranch_scc1 SK_30
    s_waitcnt vmcnt(0)
SK_30:
    s_barrier
    ds_read2st64_b32 v[160:161], v2 offset0:0 offset1:1
    ds_read2st64_b32 v[162:163], v2 offset0:2 offset1:3
    ds_read2st64_b32 v[164:165], v2 offset0:4 offset1:5
    ds_read2st64_b32 v[166:167], v2 offset0:6 offset1:7
    ds_read2st64_b32 v[168:169], v2 offset0:8 offset1:9
    ds_read2st64_b32 v[170:171], v2 offset0:10 offset1:11
    ds_read2st64_b32 v[172:173], v2 offset0:12 offset1:13
    ds_read2st64_b32 v[174:175], v2 offset0:14 offset1:15
    ds_read2st64_b32 v[176:177], v2 offset0:16 offset1:17
    ds_read2st64_b32 v[178:179], v2 offset0:18 offset1:19
    s_waitcnt lgkmcnt(11)
    ds_read2st64_b32 v[180:181], v2 offset0:20 offset1:21
    s_waitcnt lgkmcnt(11)
    ds_read2st64_b32 v[182:183], v2 offset0:22 offset1:23
    ds_read2st64_b32 v[184:185], v2 offset0:24 offset1:25
    ds_read2st64_b32 v[186:187], v2 offset0:26 offset1:27
    ds_read2st64_b32 v[188:189], v2 offset0:28 offset1:29
    ds_read2st64_b32 v[190:191], v2 offset0:30 offset1:31
    s_mov_b32 exec_lo, 0xdfffffff
    s_mov_b32 exec_hi, 0xdfffffff
    s_waitcnt lgkmcnt(15)
    v_cvt_pk_bf16_f32 v240, v160, v161
    s_waitcnt lgkmcnt(14)
    v_cvt_pk_bf16_f32 v241, v162, v163
    s_waitcnt lgkmcnt(13)
    v_cvt_pk_bf16_f32 v242, v164, v165
    s_waitcnt lgkmcnt(12)
    v_cvt_pk_bf16_f32 v243, v166, v167
    s_waitcnt lgkmcnt(11)
    v_cvt_pk_bf16_f32 v244, v168, v169
    s_waitcnt lgkmcnt(10)
    v_cvt_pk_bf16_f32 v245, v170, v171
    s_mov_b32 exec_hi, -1
    s_waitcnt lgkmcnt(9)
    v_cvt_pk_bf16_f32 v246, v172, v173
    s_waitcnt lgkmcnt(8)
    v_cvt_pk_bf16_f32 v247, v174, v175
    s_mov_b32 exec_hi, 0xdfffffff
    s_waitcnt lgkmcnt(7)
    v_cvt_pk_bf16_f32 v248, v176, v177
    s_waitcnt lgkmcnt(6)
    v_cvt_pk_bf16_f32 v249, v178, v179
    s_waitcnt lgkmcnt(5)
    v_cvt_pk_bf16_f32 v250, v180, v181
    s_waitcnt lgkmcnt(4)
    v_cvt_pk_bf16_f32 v251, v182, v183
    s_waitcnt lgkmcnt(3)
    v_cvt_pk_bf16_f32 v252, v184, v185
    s_waitcnt lgkmcnt(2)
    v_cvt_pk_bf16_f32 v253, v186, v187
    s_mov_b32 exec_hi, -1
    s_waitcnt lgkmcnt(1)
    v_cvt_pk_bf16_f32 v254, v188, v189
    s_waitcnt lgkmcnt(0)
    v_cvt_pk_bf16_f32 v255, v190, v191
    s_mov_b32 exec_lo, -1
    v_mfma_f32_32x32x16_bf16 v[192:207], v[240:243], v[224:227], 0
    v_mfma_f32_32x32x16_bf16 v[192:207], v[244:247], v[228:231], v[192:207]
    v_mfma_f32_32x32x16_bf16 v[208:223], v[248:251], v[232:235], 0
    v_mfma_f32_32x32x16_bf16 v[208:223], v[252:255], v[236:239], v[208:223]
    s_nop 7
    s_nop 1
    v_rcp_f32 v160, v205
    s_nop 0
    v_rcp_f32 v161, v221
    v_mul_f32 v162, v204, v160
    v_fma_f32 v162, v220, v161, v162
    v_add_f32 v162, 0x358637bd, v162
    v_mul_f32 v162, 0x53800000, v162
    v_rcp_f32 v162, v162
    s_nop 0
    v_mul_f32 v160, v160, v162
    v_mul_f32 v161, v161, v162
    v_mov_b32 v162, v160
    v_mov_b32 v163, v161
    s_nop 0
    v_permlane32_swap_b32 v162, v160
    v_permlane32_swap_b32 v163, v161
    v_mov_b32 v162, v161
    v_mov_b32 v163, v161
    v_mov_b32 v161, v160
    v_pk_mul_f32 v[192:193], v[192:193], v[160:161]
    v_pk_mul_f32 v[194:195], v[194:195], v[160:161]
    v_pk_mul_f32 v[196:197], v[196:197], v[160:161]
    v_pk_mul_f32 v[198:199], v[198:199], v[160:161]
    v_pk_mul_f32 v[200:201], v[200:201], v[160:161]
    v_pk_mul_f32 v[202:203], v[202:203], v[160:161]
    v_pk_mul_f32 v[204:205], v[204:205], v[160:161]
    v_pk_mul_f32 v[206:207], v[206:207], v[160:161]
    v_pk_fma_f32 v[192:193], v[208:209], v[162:163], v[192:193]
    v_pk_fma_f32 v[194:195], v[210:211], v[162:163], v[194:195]
    v_pk_fma_f32 v[196:197], v[212:213], v[162:163], v[196:197]
    v_pk_fma_f32 v[198:199], v[214:215], v[162:163], v[198:199]
    v_pk_fma_f32 v[200:201], v[216:217], v[162:163], v[200:201]
    v_pk_fma_f32 v[202:203], v[218:219], v[162:163], v[202:203]
    v_pk_fma_f32 v[204:205], v[220:221], v[162:163], v[204:205]
    v_pk_fma_f32 v[206:207], v[222:223], v[162:163], v[206:207]
    v_cvt_pk_bf16_f32 v168, v192, v193
    v_cvt_pk_bf16_f32 v169, v194, v195
    v_cvt_pk_bf16_f32 v170, v196, v197
    v_cvt_pk_bf16_f32 v171, v198, v199
    v_cvt_pk_bf16_f32 v172, v200, v201
    v_cvt_pk_bf16_f32 v173, v202, v203
    v_cvt_pk_bf16_f32 v174, v204, v205
    v_cvt_pk_bf16_f32 v175, v206, v207
    buffer_store_dwordx4 v[168:171], v10, s[20:23], s44 offen offset:0 sc1
    buffer_store_dwordx4 v[172:175], v10, s[20:23], s44 offen offset:1024 sc1
    s_cmp_lt_u32 s2, 224
    s_cbranch_scc1 SK_31
    s_waitcnt vmcnt(0) lgkmcnt(0)
    s_branch L_FIN
SK_31:
    s_waitcnt vmcnt(3)
    v_cmp_ne_u32 vcc, 0, v9
    s_cmp_eq_u64 vcc, -1
    s_cbranch_scc1 SPD_33
    s_mov_b32 s54, 50000
SPL_32:
    s_sleep 2
    buffer_load_dword v9, v8, s[20:23], 0 offen sc1
    s_waitcnt vmcnt(0)
    s_sub_u32 s54, s54, 1
    s_cbranch_scc1 SPD_33
    v_cmp_ne_u32 vcc, 0, v9
    s_cmp_eq_u64 vcc, -1
    s_cbranch_scc0 SPL_32
SPD_33:
L_H:
    s_mov_b32 s54, 50000
    s_lshl_b32 s52, s56, 10
    s_add_u32 s52, s52, s58
    buffer_load_dwordx4 v[224:227], v6, s[20:23], s52 offen offset:0 sc1
    buffer_load_dwordx4 v[228:231], v7, s[20:23], s52 offen offset:0 sc1
    buffer_load_dwordx4 v[232:235], v6, s[20:23], s52 offen offset:1024 sc1
    buffer_load_dwordx4 v[236:239], v7, s[20:23], s52 offen offset:1024 sc1
    s_add_u32 s52, s47, 0
    s_and_b32 s52, s52, 3
    s_mul_i32 s52, s52, 3
    s_add_u32 s52, s52, s55
    s_lshl_b32 s52, s52, 10
    s_add_u32 s52, s52, s58
    buffer_load_dwordx4 v[240:243], v6, s[20:23], s52 offen offset:0 sc1
    buffer_load_dwordx4 v[244:247], v7, s[20:23], s52 offen offset:0 sc1
    buffer_load_dwordx4 v[248:251], v6, s[20:23], s52 offen offset:1024 sc1
    buffer_load_dwordx4 v[252:255], v7, s[20:23], s52 offen offset:1024 sc1
HC0:
    s_waitcnt vmcnt(6)
    v_max_u32 v0, v224, v228
    v_cmp_eq_u32 vcc, -1, v0
    s_cbranch_vccnz HR0
HK0:
    v_mfma_f32_32x32x16_bf16 v[160:175], v[16:19], v[224:227], 0
    v_mfma_f32_32x32x16_bf16 v[192:207], v[20:23], v[224:227], 0
    v_mfma_f32_32x32x16_bf16 v[176:191], v[16:19], v[228:231], 0
    v_mfma_f32_32x32x16_bf16 v[208:223], v[20:23], v[228:231], 0
    buffer_load_dwordx4 v[224:227], v6, s[20:23], s52 offen offset:2048 sc1
    buffer_load_dwordx4 v[228:231], v7, s[20:23], s52 offen offset:2048 sc1
HC1:
    s_waitcnt vmcnt(6)
    v_max_u32 v0, v232, v236
    v_cmp_eq_u32 vcc, -1, v0
    s_cbranch_vccnz HR1
HK1:
    v_mfma_f32_32x32x16_bf16 v[160:175], v[24:27], v[232:235], v[160:175]
    v_mfma_f32_32x32x16_bf16 v[192:207], v[28:31], v[232:235], v[192:207]
    v_mfma_f32_32x32x16_bf16 v[176:191], v[24:27], v[236:239], v[176:191]
    v_mfma_f32_32x32x16_bf16 v[208:223], v[28:31], v[236:239], v[208:223]
    s_add_u32 s52, s47, 1
    s_and_b32 s52, s52, 3
    s_mul_i32 s52, s52, 3
    s_add_u32 s52, s52, s55
    s_lshl_b32 s52, s52, 10
    s_add_u32 s52, s52, s58
    buffer_load_dwordx4 v[232:235], v6, s[20:23], s52 offen offset:0 sc1
    buffer_load_dwordx4 v[236:239], v7, s[20:23], s52 offen offset:0 sc1
HC2:
    s_waitcnt vmcnt(6)
    v_max_u32 v0, v240, v244
    v_cmp_eq_u32 vcc, -1, v0
    s_cbranch_vccnz HR2
HK2:
    v_mfma_f32_32x32x16_bf16 v[160:175], v[32:35], v[240:243], v[160:175]
    v_mfma_f32_32x32x16_bf16 v[192:207], v[36:39], v[240:243], v[192:207]
    v_mfma_f32_32x32x16_bf16 v[176:191], v[32:35], v[244:247], v[176:191]
    v_mfma_f32_32x32x16_bf16 v[208:223], v[36:39], v[244:247], v[208:223]
    buffer_load_dwordx4 v[240:243], v6, s[20:23], s52 offen offset:1024 sc1
    buffer_load_dwordx4 v[244:247], v7, s[20:23], s52 offen offset:1024 sc1
HC3:
    s_waitcnt vmcnt(6)
    v_max_u32 v0, v248, v252
    v_cmp_eq_u32 vcc, -1, v0
    s_cbranch_vccnz HR3
HK3:
    v_mfma_f32_32x32x16_bf16 v[160:175], v[40:43], v[248:251], v[160:175]
    v_mfma_f32_32x32x16_bf16 v[192:207], v[44:47], v[248:251], v[192:207]
    v_mfma_f32_32x32x16_bf16 v[176:191], v[40:43], v[252:255], v[176:191]
    v_mfma_f32_32x32x16_bf16 v[208:223], v[44:47], v[252:255], v[208:223]
    buffer_load_dwordx4 v[248:251], v6, s[20:23], s52 offen offset:2048 sc1
    buffer_load_dwordx4 v[252:255], v7, s[20:23], s52 offen offset:2048 sc1
HC4:
    s_waitcnt vmcnt(6)
    v_max_u32 v0, v224, v228
    v_cmp_eq_u32 vcc, -1, v0
    s_cbranch_vccnz HR4
HK4:
    v_mfma_f32_32x32x16_bf16 v[160:175], v[48:51], v[224:227], v[160:175]
    v_mfma_f32_32x32x16_bf16 v[192:207], v[52:55], v[224:227], v[192:207]
    v_mfma_f32_32x32x16_bf16 v[176:191], v[48:51], v[228:231], v[176:191]
    v_mfma_f32_32x32x16_bf16 v[208:223], v[52:55], v[228:231], v[208:223]
    s_add_u32 s52, s47, 2
    s_and_b32 s52, s52, 3
    s_mul_i32 s52, s52, 3
    s_add_u32 s52, s52, s55
    s_lshl_b32 s52, s52, 10
    s_add_u32 s52, s52, s58
    buffer_load_dwordx4 v[224:227], v6, s[20:23], s52 offen offset:0 sc1
    buffer_load_dwordx4 v[228:231], v7, s[20:23], s52 offen offset:0 sc1
HC5:
    s_waitcnt vmcnt(6)
    v_max_u32 v0, v232, v236
    v_cmp_eq_u32 vcc, -1, v0
    s_cbranch_vccnz HR5
HK5:
    v_mfma_f32_32x32x16_bf16 v[160:175], v[56:59], v[232:235], v[160:175]
    v_mfma_f32_32x32x16_bf16 v[192:207], v[60:63], v[232:235], v[192:207]
    v_mfma_f32_32x32x16_bf16 v[176:191], v[56:59], v[236:239], v[176:191]
    v_mfma_f32_32x32x16_bf16 v[208:223], v[60:63], v[236:239], v[208:223]
    buffer_load_dwordx4 v[232:235], v6, s[20:23], s52 offen offset:1024 sc1
    buffer_load_dwordx4 v[236:239], v7, s[20:23], s52 offen offset:1024 sc1
HC6:
    s_waitcnt vmcnt(6)
    v_max_u32 v0, v240, v244
    v_cmp_eq_u32 vcc, -1, v0
    s_cbranch_vccnz HR6
HK6:
    v_mfma_f32_32x32x16_bf16 v[160:175], v[64:67], v[240:243], v[160:175]
    v_mfma_f32_32x32x16_bf16 v[192:207], v[68:71], v[240:243], v[192:207]
    v_mfma_f32_32x32x16_bf16 v[176:191], v[64:67], v[244:247], v[176:191]
    v_mfma_f32_32x32x16_bf16 v[208:223], v[68:71], v[244:247], v[208:223]
    buffer_load_dwordx4 v[240:243], v6, s[20:23], s52 offen offset:2048 sc1
    buffer_load_dwordx4 v[244:247], v7, s[20:23], s52 offen offset:2048 sc1
HC7:
    s_waitcnt vmcnt(6)
    v_max_u32 v0, v248, v252
    v_cmp_eq_u32 vcc, -1, v0
    s_cbranch_vccnz HR7
HK7:
    v_mfma_f32_32x32x16_bf16 v[160:175], v[72:75], v[248:251], v[160:175]
    v_mfma_f32_32x32x16_bf16 v[192:207], v[76:79], v[248:251], v[192:207]
    v_mfma_f32_32x32x16_bf16 v[176:191], v[72:75], v[252:255], v[176:191]
    v_mfma_f32_32x32x16_bf16 v[208:223], v[76:79], v[252:255], v[208:223]
    s_add_u32 s52, s47, 3
    s_and_b32 s52, s52, 3
    s_mul_i32 s52, s52, 3
    s_add_u32 s52, s52, s55
    s_lshl_b32 s52, s52, 10
    s_add_u32 s52, s52, s58
    buffer_load_dwordx4 v[248:251], v6, s[20:23], s52 offen offset:0 sc1
    buffer_load_dwordx4 v[252:255], v7, s[20:23], s52 offen offset:0 sc1
HC8:
    s_waitcnt vmcnt(6)
    v_max_u32 v0, v224, v228
    v_cmp_eq_u32 vcc, -1, v0
    s_cbranch_vccnz HR8
HK8:
    v_mfma_f32_32x32x16_bf16 v[160:175], v[80:83], v[224:227], v[160:175]
    v_mfma_f32_32x32x16_bf16 v[192:207], v[84:87], v[224:227], v[192:207]
    v_mfma_f32_32x32x16_bf16 v[176:191], v[80:83], v[228:231], v[176:191]
    v_mfma_f32_32x32x16_bf16 v[208:223], v[84:87], v[228:231], v[208:223]
    buffer_load_dwordx4 v[224:227], v6, s[20:23], s52 offen offset:1024 sc1
    buffer_load_dwordx4 v[228:231], v7, s[20:23], s52 offen offset:1024 sc1
HC9:
    s_waitcnt vmcnt(6)
    v_max_u32 v0, v232, v236
    v_cmp_eq_u32 vcc, -1, v0
    s_cbranch_vccnz HR9
HK9:
    v_mfma_f32_32x32x16_bf16 v[160:175], v[88:91], v[232:235], v[160:175]
    v_mfma_f32_32x32x16_bf16 v[192:207], v[92:95], v[232:235], v[192:207]
    v_mfma_f32_32x32x16_bf16 v[176:191], v[88:91], v[236:239], v[176:191]
    v_mfma_f32_32x32x16_bf16 v[208:223], v[92:95], v[236:239], v[208:223]
    buffer_load_dwordx4 v[232:235], v6, s[20:23], s52 offen offset:2048 sc1
    buffer_load_dwordx4 v[236:239], v7, s[20:23], s52 offen offset:2048 sc1
HC10:
    s_waitcnt vmcnt(6)
    v_max_u32 v0, v240, v244
    v_cmp_eq_u32 vcc, -1, v0
    s_cbranch_vccnz HR10
HK10:
    v_mfma_f32_32x32x16_bf16 v[160:175], v[96:99], v[240:243], v[160:175]
    v_mfma_f32_32x32x16_bf16 v[192:207], v[100:103], v[240:243], v[192:207]
    v_mfma_f32_32x32x16_bf16 v[176:191], v[96:99], v[244:247], v[176:191]
    v_mfma_f32_32x32x16_bf16 v[208:223], v[100:103], v[244:247], v[208:223]
    s_lshl_b32 s52, s3, 12
    s_add_u32 s52, s52, 114688
    s_add_u32 s52, s52, s58
    buffer_load_dwordx4 v[240:243], v6, s[20:23], s52 offen offset:0 sc1
    buffer_load_dwordx4 v[244:247], v7, s[20:23], s52 offen offset:0 sc1
HC11:
    s_waitcnt vmcnt(6)
    v_max_u32 v0, v248, v252
    v_cmp_eq_u32 vcc, -1, v0
    s_cbranch_vccnz HR11
HK11:
    v_mfma_f32_32x32x16_bf16 v[160:175], v[104:107], v[248:251], v[160:175]
    v_mfma_f32_32x32x16_bf16 v[192:207], v[108:111], v[248:251], v[192:207]
    v_mfma_f32_32x32x16_bf16 v[176:191], v[104:107], v[252:255], v[176:191]
    v_mfma_f32_32x32x16_bf16 v[208:223], v[108:111], v[252:255], v[208:223]
    buffer_load_dwordx4 v[248:251], v6, s[20:23], s52 offen offset:1024 sc1
    buffer_load_dwordx4 v[252:255], v7, s[20:23], s52 offen offset:1024 sc1
HC12:
    s_waitcnt vmcnt(6)
    v_max_u32 v0, v224, v228
    v_cmp_eq_u32 vcc, -1, v0
    s_cbranch_vccnz HR12
HK12:
    v_mfma_f32_32x32x16_bf16 v[160:175], v[112:115], v[224:227], v[160:175]
    v_mfma_f32_32x32x16_bf16 v[192:207], v[116:119], v[224:227], v[192:207]
    v_mfma_f32_32x32x16_bf16 v[176:191], v[112:115], v[228:231], v[176:191]
    v_mfma_f32_32x32x16_bf16 v[208:223], v[116:119], v[228:231], v[208:223]
    buffer_load_dwordx4 v[224:227], v6, s[20:23], s52 offen offset:2048 sc1
    buffer_load_dwordx4 v[228:231], v7, s[20:23], s52 offen offset:2048 sc1
HC13:
    s_waitcnt vmcnt(6)
    v_max_u32 v0, v232, v236
    v_cmp_eq_u32 vcc, -1, v0
    s_cbranch_vccnz HR13
HK13:
    v_mfma_f32_32x32x16_bf16 v[160:175], v[120:123], v[232:235], v[160:175]
    v_mfma_f32_32x32x16_bf16 v[192:207], v[124:127], v[232:235], v[192:207]
    v_mfma_f32_32x32x16_bf16 v[176:191], v[120:123], v[236:239], v[176:191]
    v_mfma_f32_32x32x16_bf16 v[208:223], v[124:127], v[236:239], v[208:223]
    buffer_load_dwordx4 v[232:235], v6, s[20:23], s52 offen offset:3072 sc1
    buffer_load_dwordx4 v[236:239], v7, s[20:23], s52 offen offset:3072 sc1
HC14:
    s_waitcnt vmcnt(6)
    v_max_u32 v0, v240, v244
    v_cmp_eq_u32 vcc, -1, v0
    s_cbranch_vccnz HR14
HK14:
    v_mfma_f32_32x32x16_bf16 v[160:175], v[128:131], v[240:243], v[160:175]
    v_mfma_f32_32x32x16_bf16 v[192:207], v[132:135], v[240:243], v[192:207]
    v_mfma_f32_32x32x16_bf16 v[176:191], v[128:131], v[244:247], v[176:191]
    v_mfma_f32_32x32x16_bf16 v[208:223], v[132:135], v[244:247], v[208:223]
HC15:
    s_waitcnt vmcnt(4)
    v_max_u32 v0, v248, v252
    v_cmp_eq_u32 vcc, -1, v0
    s_cbranch_vccnz HR15
HK15:
    v_mfma_f32_32x32x16_bf16 v[160:175], v[136:139], v[248:251], v[160:175]
    v_mfma_f32_32x32x16_bf16 v[192:207], v[140:143], v[248:251], v[192:207]
    v_mfma_f32_32x32x16_bf16 v[176:191], v[136:139], v[252:255], v[176:191]
    v_mfma_f32_32x32x16_bf16 v[208:223], v[140:143], v[252:255], v[208:223]
HC16:
    s_waitcnt vmcnt(2)
    v_max_u32 v0, v224, v228
    v_cmp_eq_u32 vcc, -1, v0
    s_cbranch_vccnz HR16
HK16:
    v_mfma_f32_32x32x16_bf16 v[160:175], v[144:147], v[224:227], v[160:175]
    v_mfma_f32_32x32x16_bf16 v[192:207], v[148:151], v[224:227], v[192:207]
    v_mfma_f32_32x32x16_bf16 v[176:191], v[144:147], v[228:231], v[176:191]
    v_mfma_f32_32x32x16_bf16 v[208:223], v[148:151], v[228:231], v[208:223]
HC17:
    s_waitcnt vmcnt(0)
    v_max_u32 v0, v232, v236
    v_cmp_eq_u32 vcc, -1, v0
    s_cbranch_vccnz HR17
HK17:
    v_mfma_f32_32x32x16_bf16 v[160:175], v[152:155], v[232:235], v[160:175]
    v_mfma_f32_32x32x16_bf16 v[192:207], v[156:159], v[232:235], v[192:207]
    v_mfma_f32_32x32x16_bf16 v[176:191], v[152:155], v[236:239], v[176:191]
    v_mfma_f32_32x32x16_bf16 v[208:223], v[156:159], v[236:239], v[208:223]
    s_lshl_b32 s48, s7, 1
    v_add_u32 v2, s48, v10
    v_add_u32 v3, 65536, v2
    v_add_u32 v4, 131072, v2
    s_nop 6
    ds_write_b128 v2, v[176:179] offset:0
    ds_write_b128 v2, v[180:183] offset:1024
    ds_write_b128 v2, v[192:195] offset:49152
    ds_write_b128 v2, v[196:199] offset:50176
    ds_write_b128 v3, v[208:211] offset:0
    ds_write_b128 v3, v[212:215] offset:1024
    ds_write_b128 v3, v[168:171] offset:16384
    ds_write_b128 v3, v[172:175] offset:17408
    ds_write_b128 v3, v[184:187] offset:49152
    ds_write_b128 v3, v[188:191] offset:50176
    ds_write_b128 v4, v[200:203] offset:0
    ds_write_b128 v4, v[204:207] offset:1024
    ds_write_b128 v4, v[216:219] offset:16384
    ds_write_b128 v4, v[220:223] offset:17408
    v_xor_b32 v17, 2048, v2
    v_xor_b32 v18, 4096, v2
    v_xor_b32 v19, 6144, v3
    v_xor_b32 v20, 8192, v3
    v_xor_b32 v21, 10240, v3
    v_xor_b32 v22, 12288, v4
    v_xor_b32 v23, 14336, v4
    v_lshlrev_b32 v32, 16, v12
    v_and_b32 v33, 0xffff0000, v12
    v_lshlrev_b32 v34, 16, v13
    v_and_b32 v35, 0xffff0000, v13
    v_lshlrev_b32 v36, 16, v14
    v_and_b32 v37, 0xffff0000, v14
    v_lshlrev_b32 v38, 16, v15
    v_and_b32 v39, 0xffff0000, v15
    s_waitcnt lgkmcnt(0)
    s_barrier
    ds_read_b128 v[56:59], v17 offset:0
    ds_read_b128 v[60:63], v17 offset:1024
    ds_read_b128 v[64:67], v18 offset:49152
    ds_read_b128 v[68:71], v18 offset:50176
    ds_read_b128 v[72:75], v19 offset:0
    ds_read_b128 v[76:79], v19 offset:1024
    ds_read_b128 v[80:83], v20 offset:16384
    ds_read_b128 v[84:87], v20 offset:17408
    ds_read_b128 v[88:91], v21 offset:49152
    ds_read_b128 v[92:95], v21 offset:50176
    ds_read_b128 v[96:99], v22 offset:0
    ds_read_b128 v[100:103], v22 offset:1024
    ds_read_b128 v[104:107], v23 offset:16384
    ds_read_b128 v[108:111], v23 offset:17408
    s_waitcnt lgkmcnt(13)
    v_pk_add_f32 v[160:161], v[160:161], v[56:57]
    v_pk_add_f32 v[162:163], v[162:163], v[58:59]
    s_waitcnt lgkmcnt(12)
    v_pk_add_f32 v[164:165], v[164:165], v[60:61]
    v_pk_add_f32 v[166:167], v[166:167], v[62:63]
    s_waitcnt lgkmcnt(11)
    v_pk_add_f32 v[160:161], v[160:161], v[64:65]
    v_pk_add_f32 v[162:163], v[162:163], v[66:67]
    s_waitcnt lgkmcnt(10)
    v_pk_add_f32 v[164:165], v[164:165], v[68:69]
    v_pk_add_f32 v[166:167], v[166:167], v[70:71]
    s_waitcnt lgkmcnt(9)
    v_pk_add_f32 v[160:161], v[160:161], v[72:73]
    v_pk_add_f32 v[162:163], v[162:163], v[74:75]
    s_waitcnt lgkmcnt(8)
    v_pk_add_f32 v[164:165], v[164:165], v[76:77]
    v_pk_add_f32 v[166:167], v[166:167], v[78:79]
    s_waitcnt lgkmcnt(7)
    v_pk_add_f32 v[160:161], v[160:161], v[80:81]
    v_pk_add_f32 v[162:163], v[162:163], v[82:83]
    s_waitcnt lgkmcnt(6)
    v_pk_add_f32 v[164:165], v[164:165], v[84:85]
    v_pk_add_f32 v[166:167], v[166:167], v[86:87]
    s_waitcnt lgkmcnt(5)
    v_pk_add_f32 v[160:161], v[160:161], v[88:89]
    v_pk_add_f32 v[162:163], v[162:163], v[90:91]
    s_waitcnt lgkmcnt(4)
    v_pk_add_f32 v[164:165], v[164:165], v[92:93]
    v_pk_add_f32 v[166:167], v[166:167], v[94:95]
    s_waitcnt lgkmcnt(3)
    v_pk_add_f32 v[160:161], v[160:161], v[96:97]
    v_pk_add_f32 v[162:163], v[162:163], v[98:99]
    s_waitcnt lgkmcnt(2)
    v_pk_add_f32 v[164:165], v[164:165], v[100:101]
    v_pk_add_f32 v[166:167], v[166:167], v[102:103]
    s_waitcnt lgkmcnt(1)
    v_pk_add_f32 v[160:161], v[160:161], v[104:105]
    v_pk_add_f32 v[162:163], v[162:163], v[106:107]
    s_waitcnt lgkmcnt(0)
    v_pk_add_f32 v[164:165], v[164:165], v[108:109]
    v_pk_add_f32 v[166:167], v[166:167], v[110:111]
    s_nop 0
    v_permlane32_swap_b32 v160, v164
    v_permlane32_swap_b32 v161, v165
    v_permlane32_swap_b32 v162, v166
    v_permlane32_swap_b32 v163, v167
    v_fmac_f32 v32, 0x53800000, v160
    v_fmac_f32 v33, 0x53800000, v161
    v_fmac_f32 v34, 0x53800000, v162
    v_fmac_f32 v35, 0x53800000, v163
    v_fmac_f32 v36, 0x53800000, v164
    v_fmac_f32 v37, 0x53800000, v165
    v_fmac_f32 v38, 0x53800000, v166
    v_fmac_f32 v39, 0x53800000, v167
    v_cvt_pk_bf16_f32 v40, v32, v33
    v_cvt_pk_bf16_f32 v41, v34, v35
    v_cvt_pk_bf16_f32 v42, v36, v37
    v_cvt_pk_bf16_f32 v43, v38, v39
    buffer_store_dwordx4 v[40:43], v5, s[32:35], 0 offen
L_FIN:
L_END:
    s_endpgm
XK_S:
    s_waitcnt lgkmcnt(0)
    s_nop 7
    s_nop 7
    v_mfma_f32_32x32x16_bf16 v[120:135], v[20:23], v[192:195], 0
    v_mfma_f32_32x32x16_bf16 v[120:135], v[24:27], v[196:199], v[120:135]
    s_nop 7
    s_nop 3
    v_max3_f32 v12, v120, v121, v122
    v_min3_f32 v13, v120, v121, v122
    v_max3_f32 v12, v12, v123, v124
    v_min3_f32 v13, v13, v123, v124
    v_max3_f32 v12, v12, v125, v126
    v_min3_f32 v13, v13, v125, v126
    v_max3_f32 v12, v12, v127, v128
    v_min3_f32 v13, v13, v127, v128
    v_max3_f32 v12, v12, v129, v130
    v_min3_f32 v13, v13, v129, v130
    v_max_f32 v12, v12, v131
    v_min_f32 v13, v13, v131
    s_mov_b32 exec_hi, 0
    v_max3_f32 v12, v12, v132, v133
    v_min3_f32 v13, v13, v132, v133
    v_max3_f32 v12, v12, v134, v135
    v_min3_f32 v13, v13, v134, v135
    s_mov_b32 exec_hi, -1
    v_mov_b32 v14, v12
    v_mov_b32 v15, v13
    s_nop 0
    v_permlane32_swap_b32 v12, v14
    v_permlane32_swap_b32 v13, v15
    v_max_f32 v12, v12, v14
    v_min_f32 v13, v13, v15
    v_sub_f32 v136, v13, v120
    v_sub_f32 v120, v120, v12
    v_sub_f32 v137, v13, v121
    v_sub_f32 v121, v121, v12
    v_sub_f32 v138, v13, v122
    v_sub_f32 v122, v122, v12
    v_sub_f32 v139, v13, v123
    v_sub_f32 v123, v123, v12
    v_sub_f32 v140, v13, v124
    v_sub_f32 v124, v124, v12
    v_sub_f32 v141, v13, v125
    v_sub_f32 v125, v125, v12
    v_sub_f32 v142, v13, v126
    v_sub_f32 v126, v126, v12
    v_sub_f32 v143, v13, v127
    v_sub_f32 v127, v127, v12
    v_sub_f32 v144, v13, v128
    v_sub_f32 v128, v128, v12
    v_sub_f32 v145, v13, v129
    v_sub_f32 v129, v129, v12
    v_sub_f32 v146, v13, v130
    v_sub_f32 v130, v130, v12
    v_sub_f32 v147, v13, v131
    v_sub_f32 v131, v131, v12
    v_sub_f32 v148, v13, v132
    v_sub_f32 v132, v132, v12
    v_sub_f32 v149, v13, v133
    v_sub_f32 v133, v133, v12
    v_sub_f32 v150, v13, v134
    v_sub_f32 v134, v134, v12
    v_sub_f32 v151, v13, v135
    v_sub_f32 v135, v135, v12
    v_exp_f32 v136, v136
    v_exp_f32 v120, v120
    v_exp_f32 v137, v137
    v_exp_f32 v121, v121
    v_exp_f32 v138, v138
    v_exp_f32 v122, v122
    v_exp_f32 v139, v139
    v_exp_f32 v123, v123
    v_exp_f32 v140, v140
    v_exp_f32 v124, v124
    v_exp_f32 v141, v141
    v_exp_f32 v125, v125
    v_exp_f32 v142, v142
    v_exp_f32 v126, v126
    v_exp_f32 v143, v143
    v_exp_f32 v127, v127
    v_exp_f32 v144, v144
    v_exp_f32 v128, v128
    v_exp_f32 v145, v145
    v_exp_f32 v129, v129
    v_exp_f32 v146, v146
    v_exp_f32 v130, v130
    v_exp_f32 v147, v147
    v_exp_f32 v131, v131
    v_exp_f32 v148, v148
    v_exp_f32 v132, v132
    v_exp_f32 v149, v149
    v_exp_f32 v133, v133
    v_exp_f32 v150, v150
    v_exp_f32 v134, v134
    v_exp_f32 v151, v151
    v_exp_f32 v135, v135
    s_mov_b32 exec_lo, 0
    v_mov_b32 v132, 0
    v_mov_b32 v148, 0
    v_mov_b32 v133, 0
    v_mov_b32 v149, 0
    v_mov_b32 v134, 0
    v_mov_b32 v150, 0
    v_mov_b32 v135, 0
    v_mov_b32 v151, 0
    s_mov_b32 exec_lo, -1
    s_branch XK_R
XQ_S:
    s_waitcnt lgkmcnt(0)
    s_nop 7
    s_nop 7
    v_max3_f32 v12, v240, v241, v242
    v_min3_f32 v13, v240, v241, v242
    v_max3_f32 v12, v12, v243, v244
    v_min3_f32 v13, v13, v243, v244
    v_max3_f32 v12, v12, v245, v246
    v_min3_f32 v13, v13, v245, v246
    v_max3_f32 v12, v12, v247, v248
    v_min3_f32 v13, v13, v247, v248
    v_max3_f32 v12, v12, v249, v250
    v_min3_f32 v13, v13, v249, v250
    v_max_f32 v12, v12, v251
    v_min_f32 v13, v13, v251
    s_mov_b32 exec_hi, 0
    v_max3_f32 v12, v12, v252, v253
    v_min3_f32 v13, v13, v252, v253
    v_max3_f32 v12, v12, v254, v255
    v_min3_f32 v13, v13, v254, v255
    s_mov_b32 exec_hi, -1
    v_mov_b32 v14, v12
    v_mov_b32 v15, v13
    s_nop 0
    v_permlane32_swap_b32 v12, v14
    v_permlane32_swap_b32 v13, v15
    v_max_f32 v12, v12, v14
    v_min_f32 v13, v13, v15
    v_sub_f32 v160, v13, v240
    v_sub_f32 v240, v240, v12
    v_sub_f32 v161, v13, v241
    v_sub_f32 v241, v241, v12
    v_sub_f32 v162, v13, v242
    v_sub_f32 v242, v242, v12
    v_sub_f32 v163, v13, v243
    v_sub_f32 v243, v243, v12
    v_sub_f32 v164, v13, v244
    v_sub_f32 v244, v244, v12
    v_sub_f32 v165, v13, v245
    v_sub_f32 v245, v245, v12
    v_sub_f32 v166, v13, v246
    v_sub_f32 v246, v246, v12
    v_sub_f32 v167, v13, v247
    v_sub_f32 v247, v247, v12
    v_sub_f32 v168, v13, v248
    v_sub_f32 v248, v248, v12
    v_sub_f32 v169, v13, v249
    v_sub_f32 v249, v249, v12
    v_sub_f32 v170, v13, v250
    v_sub_f32 v250, v250, v12
    v_sub_f32 v171, v13, v251
    v_sub_f32 v251, v251, v12
    v_sub_f32 v172, v13, v252
    v_sub_f32 v252, v252, v12
    v_sub_f32 v173, v13, v253
    v_sub_f32 v253, v253, v12
    v_sub_f32 v174, v13, v254
    v_sub_f32 v254, v254, v12
    v_sub_f32 v175, v13, v255
    v_sub_f32 v255, v255, v12
    v_exp_f32 v160, v160
    v_exp_f32 v240, v240
    v_exp_f32 v161, v161
    v_exp_f32 v241, v241
    v_exp_f32 v162, v162
    v_exp_f32 v242, v242
    v_exp_f32 v163, v163
    v_exp_f32 v243, v243
    v_exp_f32 v164, v164
    v_exp_f32 v244, v244
    v_exp_f32 v165, v165
    v_exp_f32 v245, v245
    v_exp_f32 v166, v166
    v_exp_f32 v246, v246
    v_exp_f32 v167, v167
    v_exp_f32 v247, v247
    v_exp_f32 v168, v168
    v_exp_f32 v248, v248
    v_exp_f32 v169, v169
    v_exp_f32 v249, v249
    v_exp_f32 v170, v170
    v_exp_f32 v250, v250
    v_exp_f32 v171, v171
    v_exp_f32 v251, v251
    v_exp_f32 v172, v172
    v_exp_f32 v252, v252
    v_exp_f32 v173, v173
    v_exp_f32 v253, v253
    v_exp_f32 v174, v174
    v_exp_f32 v254, v254
    v_exp_f32 v175, v175
    v_exp_f32 v255, v255
    s_mov_b32 exec_lo, 0
    v_mov_b32 v252, 0
    v_mov_b32 v172, 0
    v_mov_b32 v253, 0
    v_mov_b32 v173, 0
    v_mov_b32 v254, 0
    v_mov_b32 v174, 0
    v_mov_b32 v255, 0
    v_mov_b32 v175, 0
    s_mov_b32 exec_lo, -1
    s_branch XQ_R
HR0:
    s_sub_u32 s54, s54, 1
    s_cbranch_scc1 HX0
    s_sleep 1
    s_lshl_b32 s48, s56, 10
    s_add_u32 s48, s48, s58
    buffer_load_dwordx4 v[224:227], v6, s[20:23], s48 offen offset:0 sc1
    buffer_load_dwordx4 v[228:231], v7, s[20:23], s48 offen offset:0 sc1
    s_waitcnt vmcnt(0)
    s_branch HC0
HX0:
    s_mov_b32 s54, 0
    s_branch HK0
HR1:
    s_sub_u32 s54, s54, 1
    s_cbranch_scc1 HX1
    s_sleep 1
    s_lshl_b32 s48, s56, 10
    s_add_u32 s48, s48, s58
    buffer_load_dwordx4 v[232:235], v6, s[20:23], s48 offen offset:1024 sc1
    buffer_load_dwordx4 v[236:239], v7, s[20:23], s48 offen offset:1024 sc1
    s_waitcnt vmcnt(0)
    s_branch HC1
HX1:
    s_mov_b32 s54, 0
    s_branch HK1
HR2:
    s_sub_u32 s54, s54, 1
    s_cbranch_scc1 HX2
    s_sleep 1
    s_add_u32 s48, s47, 0
    s_and_b32 s48, s48, 3
    s_mul_i32 s48, s48, 3
    s_add_u32 s48, s48, s55
    s_lshl_b32 s48, s48, 10
    s_add_u32 s48, s48, s58
    buffer_load_dwordx4 v[240:243], v6, s[20:23], s48 offen offset:0 sc1
    buffer_load_dwordx4 v[244:247], v7, s[20:23], s48 offen offset:0 sc1
    s_waitcnt vmcnt(0)
    s_branch HC2
HX2:
    s_mov_b32 s54, 0
    s_branch HK2
HR3:
    s_sub_u32 s54, s54, 1
    s_cbranch_scc1 HX3
    s_sleep 1
    s_add_u32 s48, s47, 0
    s_and_b32 s48, s48, 3
    s_mul_i32 s48, s48, 3
    s_add_u32 s48, s48, s55
    s_lshl_b32 s48, s48, 10
    s_add_u32 s48, s48, s58
    buffer_load_dwordx4 v[248:251], v6, s[20:23], s48 offen offset:1024 sc1
    buffer_load_dwordx4 v[252:255], v7, s[20:23], s48 offen offset:1024 sc1
    s_waitcnt vmcnt(0)
    s_branch HC3
HX3:
    s_mov_b32 s54, 0
    s_branch HK3
HR4:
    s_sub_u32 s54, s54, 1
    s_cbranch_scc1 HX4
    s_sleep 1
    s_add_u32 s48, s47, 0
    s_and_b32 s48, s48, 3
    s_mul_i32 s48, s48, 3
    s_add_u32 s48, s48, s55
    s_lshl_b32 s48, s48, 10
    s_add_u32 s48, s48, s58
    buffer_load_dwordx4 v[224:227], v6, s[20:23], s48 offen offset:2048 sc1
    buffer_load_dwordx4 v[228:231], v7, s[20:23], s48 offen offset:2048 sc1
    s_waitcnt vmcnt(0)
    s_branch HC4
HX4:
    s_mov_b32 s54, 0
    s_branch HK4
HR5:
    s_sub_u32 s54, s54, 1
    s_cbranch_scc1 HX5
    s_sleep 1
    s_add_u32 s48, s47, 1
    s_and_b32 s48, s48, 3
    s_mul_i32 s48, s48, 3
    s_add_u32 s48, s48, s55
    s_lshl_b32 s48, s48, 10
    s_add_u32 s48, s48, s58
    buffer_load_dwordx4 v[232:235], v6, s[20:23], s48 offen offset:0 sc1
    buffer_load_dwordx4 v[236:239], v7, s[20:23], s48 offen offset:0 sc1
    s_waitcnt vmcnt(0)
    s_branch HC5
HX5:
    s_mov_b32 s54, 0
    s_branch HK5
HR6:
    s_sub_u32 s54, s54, 1
    s_cbranch_scc1 HX6
    s_sleep 1
    s_add_u32 s48, s47, 1
    s_and_b32 s48, s48, 3
    s_mul_i32 s48, s48, 3
    s_add_u32 s48, s48, s55
    s_lshl_b32 s48, s48, 10
    s_add_u32 s48, s48, s58
    buffer_load_dwordx4 v[240:243], v6, s[20:23], s48 offen offset:1024 sc1
    buffer_load_dwordx4 v[244:247], v7, s[20:23], s48 offen offset:1024 sc1
    s_waitcnt vmcnt(0)
    s_branch HC6
HX6:
    s_mov_b32 s54, 0
    s_branch HK6
HR7:
    s_sub_u32 s54, s54, 1
    s_cbranch_scc1 HX7
    s_sleep 1
    s_add_u32 s48, s47, 1
    s_and_b32 s48, s48, 3
    s_mul_i32 s48, s48, 3
    s_add_u32 s48, s48, s55
    s_lshl_b32 s48, s48, 10
    s_add_u32 s48, s48, s58
    buffer_load_dwordx4 v[248:251], v6, s[20:23], s48 offen offset:2048 sc1
    buffer_load_dwordx4 v[252:255], v7, s[20:23], s48 offen offset:2048 sc1
    s_waitcnt vmcnt(0)
    s_branch HC7
HX7:
    s_mov_b32 s54, 0
    s_branch HK7
HR8:
    s_sub_u32 s54, s54, 1
    s_cbranch_scc1 HX8
    s_sleep 1
    s_add_u32 s48, s47, 2
    s_and_b32 s48, s48, 3
    s_mul_i32 s48, s48, 3
    s_add_u32 s48, s48, s55
    s_lshl_b32 s48, s48, 10
    s_add_u32 s48, s48, s58
    buffer_load_dwordx4 v[224:227], v6, s[20:23], s48 offen offset:0 sc1
    buffer_load_dwordx4 v[228:231], v7, s[20:23], s48 offen offset:0 sc1
    s_waitcnt vmcnt(0)
    s_branch HC8
HX8:
    s_mov_b32 s54, 0
    s_branch HK8
HR9:
    s_sub_u32 s54, s54, 1
    s_cbranch_scc1 HX9
    s_sleep 1
    s_add_u32 s48, s47, 2
    s_and_b32 s48, s48, 3
    s_mul_i32 s48, s48, 3
    s_add_u32 s48, s48, s55
    s_lshl_b32 s48, s48, 10
    s_add_u32 s48, s48, s58
    buffer_load_dwordx4 v[232:235], v6, s[20:23], s48 offen offset:1024 sc1
    buffer_load_dwordx4 v[236:239], v7, s[20:23], s48 offen offset:1024 sc1
    s_waitcnt vmcnt(0)
    s_branch HC9
HX9:
    s_mov_b32 s54, 0
    s_branch HK9
HR10:
    s_sub_u32 s54, s54, 1
    s_cbranch_scc1 HX10
    s_sleep 1
    s_add_u32 s48, s47, 2
    s_and_b32 s48, s48, 3
    s_mul_i32 s48, s48, 3
    s_add_u32 s48, s48, s55
    s_lshl_b32 s48, s48, 10
    s_add_u32 s48, s48, s58
    buffer_load_dwordx4 v[240:243], v6, s[20:23], s48 offen offset:2048 sc1
    buffer_load_dwordx4 v[244:247], v7, s[20:23], s48 offen offset:2048 sc1
    s_waitcnt vmcnt(0)
    s_branch HC10
HX10:
    s_mov_b32 s54, 0
    s_branch HK10
HR11:
    s_sub_u32 s54, s54, 1
    s_cbranch_scc1 HX11
    s_sleep 1
    s_add_u32 s48, s47, 3
    s_and_b32 s48, s48, 3
    s_mul_i32 s48, s48, 3
    s_add_u32 s48, s48, s55
    s_lshl_b32 s48, s48, 10
    s_add_u32 s48, s48, s58
    buffer_load_dwordx4 v[248:251], v6, s[20:23], s48 offen offset:0 sc1
    buffer_load_dwordx4 v[252:255], v7, s[20:23], s48 offen offset:0 sc1
    s_waitcnt vmcnt(0)
    s_branch HC11
HX11:
    s_mov_b32 s54, 0
    s_branch HK11
HR12:
    s_sub_u32 s54, s54, 1
    s_cbranch_scc1 HX12
    s_sleep 1
    s_add_u32 s48, s47, 3
    s_and_b32 s48, s48, 3
    s_mul_i32 s48, s48, 3
    s_add_u32 s48, s48, s55
    s_lshl_b32 s48, s48, 10
    s_add_u32 s48, s48, s58
    buffer_load_dwordx4 v[224:227], v6, s[20:23], s48 offen offset:1024 sc1
    buffer_load_dwordx4 v[228:231], v7, s[20:23], s48 offen offset:1024 sc1
    s_waitcnt vmcnt(0)
    s_branch HC12
HX12:
    s_mov_b32 s54, 0
    s_branch HK12
HR13:
    s_sub_u32 s54, s54, 1
    s_cbranch_scc1 HX13
    s_sleep 1
    s_add_u32 s48, s47, 3
    s_and_b32 s48, s48, 3
    s_mul_i32 s48, s48, 3
    s_add_u32 s48, s48, s55
    s_lshl_b32 s48, s48, 10
    s_add_u32 s48, s48, s58
    buffer_load_dwordx4 v[232:235], v6, s[20:23], s48 offen offset:2048 sc1
    buffer_load_dwordx4 v[236:239], v7, s[20:23], s48 offen offset:2048 sc1
    s_waitcnt vmcnt(0)
    s_branch HC13
HX13:
    s_mov_b32 s54, 0
    s_branch HK13
HR14:
    s_sub_u32 s54, s54, 1
    s_cbranch_scc1 HX14
    s_sleep 1
    s_lshl_b32 s48, s3, 12
    s_add_u32 s48, s48, 114688
    s_add_u32 s48, s48, s58
    buffer_load_dwordx4 v[240:243], v6, s[20:23], s48 offen offset:0 sc1
    buffer_load_dwordx4 v[244:247], v7, s[20:23], s48 offen offset:0 sc1
    s_waitcnt vmcnt(0)
    s_branch HC14
HX14:
    s_mov_b32 s54, 0
    s_branch HK14
HR15:
    s_sub_u32 s54, s54, 1
    s_cbranch_scc1 HX15
    s_sleep 1
    s_lshl_b32 s48, s3, 12
    s_add_u32 s48, s48, 114688
    s_add_u32 s48, s48, s58
    buffer_load_dwordx4 v[248:251], v6, s[20:23], s48 offen offset:1024 sc1
    buffer_load_dwordx4 v[252:255], v7, s[20:23], s48 offen offset:1024 sc1
    s_waitcnt vmcnt(0)
    s_branch HC15
HX15:
    s_mov_b32 s54, 0
    s_branch HK15
HR16:
    s_sub_u32 s54, s54, 1
    s_cbranch_scc1 HX16
    s_sleep 1
    s_lshl_b32 s48, s3, 12
    s_add_u32 s48, s48, 114688
    s_add_u32 s48, s48, s58
    buffer_load_dwordx4 v[224:227], v6, s[20:23], s48 offen offset:2048 sc1
    buffer_load_dwordx4 v[228:231], v7, s[20:23], s48 offen offset:2048 sc1
    s_waitcnt vmcnt(0)
    s_branch HC16
HX16:
    s_mov_b32 s54, 0
    s_branch HK16
HR17:
    s_sub_u32 s54, s54, 1
    s_cbranch_scc1 HX17
    s_sleep 1
    s_lshl_b32 s48, s3, 12
    s_add_u32 s48, s48, 114688
    s_add_u32 s48, s48, s58
    buffer_load_dwordx4 v[232:235], v6, s[20:23], s48 offen offset:3072 sc1
    buffer_load_dwordx4 v[236:239], v7, s[20:23], s48 offen offset:3072 sc1
    s_waitcnt vmcnt(0)
    s_branch HC17
HX17:
    s_mov_b32 s54, 0
    s_branch HK17
.section .rodata,"a"
.p2align 6
.amdhsa_kernel parallel_sum__linear_kernel_hedgehog__glu_gated_reglu__prompt_kernel
  .amdhsa_next_free_vgpr 256
  .amdhsa_next_free_sgpr 102
  .amdhsa_accum_offset 256
  .amdhsa_group_segment_fixed_size 0
  .amdhsa_kernarg_size 88
  .amdhsa_user_sgpr_count 2
  .amdhsa_user_sgpr_kernarg_segment_ptr 1
  .amdhsa_system_sgpr_workgroup_id_x 1
.end_amdhsa_kernel
```
